```python
import torch

def _softmax(x, axis=-1):
    return torch.softmax(x, dim=axis)
def _gelu(x):
    return torch.nn.functional.gelu(x, approximate="tanh")
def _silu(x):
    return torch.nn.functional.silu(x)
def _sigmoid(x):
    return torch.sigmoid(x)
def _layernorm(x, axis=-1, eps=1e-5):
    m = x.mean(dim=axis, keepdim=True)
    v = x.var(dim=axis, keepdim=True, unbiased=False)
    return (x - m) / torch.sqrt(v + eps)
def _scatter_add(tgt, idx, src, axis=0):
    return tgt.clone().index_add_(axis, idx, src)
def _segment_sum(src, seg, n):
    out = torch.zeros((n,) + src.shape[1:], dtype=src.dtype)
    return out.index_add_(0, seg, src)
def _pad(x, pw):
    flat = tuple(v for pair in reversed(pw) for v in pair)
    return torch.nn.functional.pad(x, flat)

kernel_name = 'parallel_sum__linear_kernel_hedgehog__dense_activation_squared_relu__prompt'

def setup_inputs():

    _w = (lambda a: (lambda t: t.to(torch.bfloat16) if t.is_floating_point() else t)(torch.as_tensor(a)))
    def _A_setup():
        B, S, D, H = 1, 2048, 512, 32
        Dh = D // H
        return {
            "x": _w((lambda *s: torch.randn(*s, dtype=torch.bfloat16) * 0.05)(B, S, D)),
            "wqkv": _w((lambda *s: torch.randn(*s, dtype=torch.bfloat16) * 0.8)(D, 3 * D)),
            "w_phi": _w((lambda *s: torch.randn(*s, dtype=torch.bfloat16) * 0.8)(H, Dh, Dh) * (Dh ** -0.5)),
            "wo": _w((lambda *s: torch.randn(*s, dtype=torch.bfloat16) * 0.2)(D, D)),
        }
    _A_in = _A_setup()

    def _B_setup():
        B, S, D, F = 1, 2048, 512, 1376
        return {
            "x": _w((lambda *s: torch.randn(*s, dtype=torch.bfloat16) * 0.05)(B, S, D)),
            "w1": _w((lambda *s: torch.randn(*s, dtype=torch.bfloat16) * 0.05)(D, F)),
            "b1": _w((lambda *s: torch.randn(*s, dtype=torch.bfloat16) * 0.8)(F)),
            "w2": _w((lambda *s: torch.randn(*s, dtype=torch.bfloat16) * 0.05)(F, D)),
            "b2": _w((lambda *s: torch.randn(*s, dtype=torch.bfloat16) * 3.2)(D)),
        }
    _B_in = _B_setup()

    return {
        "A_x": _A_in["x"],
        "A_wqkv": _A_in["wqkv"],
        "A_w_phi": _A_in["w_phi"],
        "A_wo": _A_in["wo"],
        "B_x": _B_in["x"],
        "B_w1": _B_in["w1"],
        "B_b1": _B_in["b1"],
        "B_w2": _B_in["w2"],
        "B_b2": _B_in["b2"],
    }

def reference(A_x, A_wqkv, A_w_phi, A_wo, B_x, B_w1, B_b1, B_w2, B_b2):
    def _A_ref(x, wqkv, w_phi, wo):
        B, S, D = x.shape
        H = 32; Dh = D // H
        qkv = (lambda x, *d: x.permute(*d))((x @ wqkv).reshape(B, S, 3, H, Dh), 2, 0, 3, 1, 4)
        q, k, v = qkv[0], qkv[1], qkv[2]
        pq = torch.einsum("bhsd,hdf->bhsf", q, w_phi)
        pk = torch.einsum("bhsd,hdf->bhsf", k, w_phi)
        phi_q = torch.concatenate([_softmax(pq, axis=-1), _softmax(-pq, axis=-1)], axis=-1)
        phi_k = torch.concatenate([_softmax(pk, axis=-1), _softmax(-pk, axis=-1)], axis=-1)
        kv = torch.einsum("bhsf,bhsd->bhfd", phi_k, v)
        z  = torch.einsum("bhsf->bhf", phi_k)
        num = torch.einsum("bhqf,bhfd->bhqd", phi_q, kv)
        den = torch.einsum("bhqf,bhf->bhq", phi_q, z)[..., None] + 1e-6
        o = num / den
        return (lambda x, *d: x.permute(*d))(o, 0, 2, 1, 3).reshape(B, S, D) @ wo

    def _B_ref(x, w1, b1, w2, b2):
        h = torch.einsum("bsd,df->bsf", x, w1) + b1
        zero = torch.zeros_like(h)
        r = torch.where(h > zero, h, zero)
        h = r * r
        out = torch.einsum("bsf,fd->bsd", h, w2) + b2
        return out

    x = A_x
    xn = _layernorm(x, axis=-1)
    return x + _A_ref(xn, A_wqkv, A_w_phi, A_wo) + _B_ref(xn, B_w1, B_b1, B_w2, B_b2)
```

```asm
; @launch grid=(256,1,1) block=(512,1,1) lds=161920
.amdgcn_target "amdgcn-amd-amdhsa--gfx950"
.text
    .globl parallel_sum__linear_kernel_hedgehog__dense_activation_squared_relu__prompt_kernel
    .p2align 8
    .type parallel_sum__linear_kernel_hedgehog__dense_activation_squared_relu__prompt_kernel,@function
parallel_sum__linear_kernel_hedgehog__dense_activation_squared_relu__prompt_kernel:
    s_cmp_ge_u32 s2, 256
    s_cbranch_scc1 L_end
    s_load_dwordx8 s[4:11], s[0:1], 0
    s_load_dwordx8 s[12:19], s[0:1], 40
    s_load_dwordx4 s[20:23], s[0:1], 72
    s_load_dwordx2 s[24:25], s[0:1], 88
    v_lshrrev_b32 v1, 6, v0
    v_and_b32 v0, 63, v0
    s_and_b32 s64, s2, 7
    v_readfirstlane_b32 s26, v1
    s_bfe_u32 s66, s2, 0x10006
    s_lshr_b32 s28, s2, 7
    s_bfe_u32 s29, s2, 0x30003
    s_mov_b32 s32, s29
    s_lshl_b32 s27, s64, 1
    s_add_u32 s27, s27, s66
    s_lshl_b32 s67, s66, 2
    s_add_u32 s67, s67, s29
    s_add_u32 s67, s67, s64
    s_and_b32 s30, s67, 7
    s_lshl_b32 s31, s27, 1
    s_add_u32 s31, s31, s28
    s_lshl_b32 s67, s31, 1
    s_add_u32 s67, s67, s29
    s_and_b32 s3, s67, 7
    s_and_b32 s33, s26, 3
    s_cmp_lt_u32 s26, 4
    s_cbranch_scc1 L_C
    s_cmp_ge_u32 s26, 6
    s_cbranch_scc1 L_S
L_L:
    s_setprio 2
    v_lshrrev_b32 v10, 3, v0
    v_and_b32 v11, 7, v0
    v_lshrrev_b32 v12, 4, v0
    v_xor_b32 v13, v11, v12
    v_lshlrev_b32 v14, 10, v10
    v_lshl_add_u32 v2, v13, 4, v14
    v_xor_b32 v13, 4, v13
    v_lshl_add_u32 v3, v13, 4, v14
    s_lshl_b32 s72, s27, 17
    s_lshl_b32 s77, s33, 16
    s_add_u32 s72, s72, s77
    s_lshl_b32 s70, s33, 13
    s_lshl_b32 s71, s33, 12
    s_mov_b32 s38, 2097152
    s_mov_b32 s39, 0x20000
    s_lshl_b32 s74, s30, 7
    s_add_u32 s74, s74, s72
    s_waitcnt lgkmcnt(0)
    s_mov_b32 s36, s4
    s_mov_b32 s37, s5
    s_add_u32 m0, s70, 0
    s_add_u32 s77, s74, 0
    buffer_load_dwordx4 v2, s[36:39], s77 offen  lds
    s_add_u32 m0, s70, 1024
    s_add_u32 s77, s74, 8192
    buffer_load_dwordx4 v3, s[36:39], s77 offen  lds
    s_add_u32 m0, s70, 2048
    s_add_u32 s77, s74, 16384
    buffer_load_dwordx4 v2, s[36:39], s77 offen  lds
    s_add_u32 m0, s70, 3072
    s_add_u32 s77, s74, 24576
    buffer_load_dwordx4 v3, s[36:39], s77 offen  lds
    s_add_u32 m0, s70, 4096
    s_add_u32 s77, s74, 32768
    buffer_load_dwordx4 v2, s[36:39], s77 offen  lds
    s_add_u32 m0, s70, 5120
    s_add_u32 s77, s74, 40960
    buffer_load_dwordx4 v3, s[36:39], s77 offen  lds
    s_add_u32 m0, s70, 6144
    s_add_u32 s77, s74, 49152
    buffer_load_dwordx4 v2, s[36:39], s77 offen  lds
    s_add_u32 m0, s70, 7168
    s_add_u32 s77, s74, 57344
    buffer_load_dwordx4 v3, s[36:39], s77 offen  lds
    v_and_b32 v12, 1, v12
    v_lshlrev_b32 v12, 2, v12
    v_xor_b32 v13, v11, v12
    s_cmp_eq_u32 s28, 0
    s_cselect_b32 s40, s6, s12
    s_cselect_b32 s41, s7, s13
    s_mov_b32 s43, 0x20000
    s_mov_b32 s77, 1572864
    s_cselect_b32 s42, s77, 1409024
    s_movk_i32 s77, 3072
    s_cselect_b32 s76, s77, 2752
    v_mul_lo_u32 v14, v10, s76
    s_min_u32 s77, s29, 3
    s_mul_i32 s35, s29, 5
    s_add_u32 s35, s35, s77
    s_lshl_b32 s35, s35, 6
    s_lshl_b32 s77, s29, 7
    s_cmp_eq_u32 s28, 0
    s_cselect_b32 s64, s77, s35
    s_movk_i32 s77, 1024
    s_cselect_b32 s56, s77, 0
    s_movk_i32 s77, 2048
    s_cselect_b32 s60, s77, 128
    s_cselect_b32 s77, 0, 256
    v_lshl_add_u32 v4, v13, 4, v14
    s_lshl_b32 s73, s76, 5
    s_mul_i32 s73, s73, s33
    s_add_u32 s64, s64, s73
    s_add_u32 s56, s56, s64
    s_add_u32 s60, s60, s64
    s_add_u32 s64, s64, s77
    s_lshl_b32 s77, s76, 3
    s_add_u32 s57, s56, s77
    s_add_u32 s58, s57, s77
    s_add_u32 s59, s58, s77
    s_add_u32 s61, s60, s77
    s_add_u32 s62, s61, s77
    s_add_u32 s63, s62, s77
    s_add_u32 s65, s64, s77
    s_add_u32 s66, s65, s77
    s_add_u32 s67, s66, s77
    s_lshl_b32 s73, s76, 6
    s_mul_i32 s75, s30, s73
    s_add_u32 m0, s71, 65536
    s_add_u32 s77, s75, s56
    buffer_load_dwordx4 v4, s[40:43], s77 offen  lds
    s_add_u32 m0, s71, 73728
    s_add_u32 s77, s75, s60
    buffer_load_dwordx4 v4, s[40:43], s77 offen  lds
    s_add_u32 m0, s71, 66560
    s_add_u32 s77, s75, s57
    buffer_load_dwordx4 v4, s[40:43], s77 offen  lds
    s_add_u32 m0, s71, 74752
    s_add_u32 s77, s75, s61
    buffer_load_dwordx4 v4, s[40:43], s77 offen  lds
    s_add_u32 m0, s71, 67584
    s_add_u32 s77, s75, s58
    buffer_load_dwordx4 v4, s[40:43], s77 offen  lds
    s_add_u32 m0, s71, 75776
    s_add_u32 s77, s75, s62
    buffer_load_dwordx4 v4, s[40:43], s77 offen  lds
    s_add_u32 m0, s71, 68608
    s_add_u32 s77, s75, s59
    buffer_load_dwordx4 v4, s[40:43], s77 offen  lds
    s_add_u32 m0, s71, 76800
    s_add_u32 s77, s75, s63
    buffer_load_dwordx4 v4, s[40:43], s77 offen  lds
    s_cmp_ge_u32 s29, 3
    s_cselect_b32 s77, s28, 0
    s_lshl_b32 s77, s77, 30
    v_lshrrev_b32 v12, 2, v13
    v_mul_lo_u32 v12, v12, s77
    v_add_u32 v5, v4, v12
    s_add_u32 m0, s71, 131072
    s_add_u32 s77, s75, s64
    buffer_load_dwordx4 v5, s[40:43], s77 offen  lds
    s_add_u32 m0, s71, 132096
    s_add_u32 s77, s75, s65
    buffer_load_dwordx4 v5, s[40:43], s77 offen  lds
    s_add_u32 m0, s71, 133120
    s_add_u32 s77, s75, s66
    buffer_load_dwordx4 v5, s[40:43], s77 offen  lds
    s_add_u32 m0, s71, 134144
    s_add_u32 s77, s75, s67
    buffer_load_dwordx4 v5, s[40:43], s77 offen  lds
    s_add_u32 s77, s30, 1
    s_and_b32 s77, s77, 7
    s_lshl_b32 s74, s77, 7
    s_add_u32 s74, s74, s72
    s_mul_i32 s75, s77, s73
    s_add_u32 m0, s70, 16384
    s_add_u32 s77, s74, 0
    buffer_load_dwordx4 v2, s[36:39], s77 offen  lds
    s_add_u32 m0, s70, 17408
    s_add_u32 s77, s74, 8192
    buffer_load_dwordx4 v3, s[36:39], s77 offen  lds
    s_add_u32 m0, s70, 18432
    s_add_u32 s77, s74, 16384
    buffer_load_dwordx4 v2, s[36:39], s77 offen  lds
    s_add_u32 m0, s70, 19456
    s_add_u32 s77, s74, 24576
    buffer_load_dwordx4 v3, s[36:39], s77 offen  lds
    s_add_u32 m0, s70, 20480
    s_add_u32 s77, s74, 32768
    buffer_load_dwordx4 v2, s[36:39], s77 offen  lds
    s_add_u32 m0, s70, 21504
    s_add_u32 s77, s74, 40960
    buffer_load_dwordx4 v3, s[36:39], s77 offen  lds
    s_add_u32 m0, s70, 22528
    s_add_u32 s77, s74, 49152
    buffer_load_dwordx4 v2, s[36:39], s77 offen  lds
    s_add_u32 m0, s70, 23552
    s_add_u32 s77, s74, 57344
    buffer_load_dwordx4 v3, s[36:39], s77 offen  lds
    s_add_u32 m0, s71, 81920
    s_add_u32 s77, s75, s56
    buffer_load_dwordx4 v4, s[40:43], s77 offen  lds
    s_add_u32 m0, s71, 90112
    s_add_u32 s77, s75, s60
    buffer_load_dwordx4 v4, s[40:43], s77 offen  lds
    s_add_u32 m0, s71, 82944
    s_add_u32 s77, s75, s57
    buffer_load_dwordx4 v4, s[40:43], s77 offen  lds
    s_add_u32 m0, s71, 91136
    s_add_u32 s77, s75, s61
    buffer_load_dwordx4 v4, s[40:43], s77 offen  lds
    s_add_u32 m0, s71, 83968
    s_add_u32 s77, s75, s58
    buffer_load_dwordx4 v4, s[40:43], s77 offen  lds
    s_add_u32 m0, s71, 92160
    s_add_u32 s77, s75, s62
    buffer_load_dwordx4 v4, s[40:43], s77 offen  lds
    s_add_u32 m0, s71, 84992
    s_add_u32 s77, s75, s59
    buffer_load_dwordx4 v4, s[40:43], s77 offen  lds
    s_add_u32 m0, s71, 93184
    s_add_u32 s77, s75, s63
    buffer_load_dwordx4 v4, s[40:43], s77 offen  lds
    s_add_u32 s77, s75, s64
    buffer_load_dwordx4 v[64:67], v5, s[40:43], s77 offen
    s_add_u32 s77, s75, s65
    buffer_load_dwordx4 v[64:67], v5, s[40:43], s77 offen
    s_add_u32 s77, s75, s66
    buffer_load_dwordx4 v[64:67], v5, s[40:43], s77 offen
    s_add_u32 s77, s75, s67
    buffer_load_dwordx4 v[64:67], v5, s[40:43], s77 offen
    s_mov_b32 s52, s24
    s_mov_b32 s53, s25
    s_mov_b32 s54, 268435456
    s_mov_b32 s55, 0x20000
    s_mov_b32 s44, s16
    s_mov_b32 s45, s17
    s_mov_b32 s46, 1409024
    s_mov_b32 s47, 0x20000
    s_mov_b32 s48, s10
    s_mov_b32 s49, s11
    s_mov_b32 s50, 524288
    s_mov_b32 s51, 0x20000
    v_lshrrev_b32 v10, 3, v0
    v_and_b32 v11, 7, v0
    v_bfe_u32 v12, v0, 4, 1
    v_lshlrev_b32 v12, 2, v12
    v_xor_b32 v11, v11, v12
    v_lshlrev_b32 v10, 10, v10
    v_lshl_add_u32 v6, v11, 4, v10
    v_lshlrev_b32 v7, 4, v0
    v_lshlrev_b32 v8, 2, v0
    s_lshl_b32 s76, s33, 2
    s_add_u32 s76, s76, 131072
    v_mov_b32 v28, s76
    v_mov_b32 v27, 131072
    v_mov_b32 v20, 0
    s_waitcnt vmcnt(24)
    s_barrier
    s_add_u32 s77, s30, 2
    s_and_b32 s77, s77, 7
    s_lshl_b32 s74, s77, 7
    s_add_u32 s74, s74, s72
    s_mul_i32 s75, s77, s73
    s_add_u32 m0, s70, 32768
    s_add_u32 s77, s74, 0
    buffer_load_dwordx4 v2, s[36:39], s77 offen  lds
    s_add_u32 m0, s70, 33792
    s_add_u32 s77, s74, 8192
    buffer_load_dwordx4 v3, s[36:39], s77 offen  lds
    s_add_u32 m0, s70, 34816
    s_add_u32 s77, s74, 16384
    buffer_load_dwordx4 v2, s[36:39], s77 offen  lds
    s_add_u32 m0, s70, 35840
    s_add_u32 s77, s74, 24576
    buffer_load_dwordx4 v3, s[36:39], s77 offen  lds
    s_add_u32 m0, s70, 36864
    s_add_u32 s77, s74, 32768
    buffer_load_dwordx4 v2, s[36:39], s77 offen  lds
    s_add_u32 m0, s70, 37888
    s_add_u32 s77, s74, 40960
    buffer_load_dwordx4 v3, s[36:39], s77 offen  lds
    s_add_u32 m0, s70, 38912
    s_add_u32 s77, s74, 49152
    buffer_load_dwordx4 v2, s[36:39], s77 offen  lds
    s_add_u32 m0, s70, 39936
    s_add_u32 s77, s74, 57344
    buffer_load_dwordx4 v3, s[36:39], s77 offen  lds
    s_add_u32 m0, s71, 98304
    s_add_u32 s77, s75, s56
    buffer_load_dwordx4 v4, s[40:43], s77 offen  lds
    s_add_u32 m0, s71, 106496
    s_add_u32 s77, s75, s60
    buffer_load_dwordx4 v4, s[40:43], s77 offen  lds
    s_add_u32 m0, s71, 99328
    s_add_u32 s77, s75, s57
    buffer_load_dwordx4 v4, s[40:43], s77 offen  lds
    s_add_u32 m0, s71, 107520
    s_add_u32 s77, s75, s61
    buffer_load_dwordx4 v4, s[40:43], s77 offen  lds
    s_add_u32 m0, s71, 100352
    s_add_u32 s77, s75, s58
    buffer_load_dwordx4 v4, s[40:43], s77 offen  lds
    s_add_u32 m0, s71, 108544
    s_add_u32 s77, s75, s62
    buffer_load_dwordx4 v4, s[40:43], s77 offen  lds
    s_add_u32 m0, s71, 101376
    s_add_u32 s77, s75, s59
    buffer_load_dwordx4 v4, s[40:43], s77 offen  lds
    s_add_u32 m0, s71, 109568
    s_add_u32 s77, s75, s63
    buffer_load_dwordx4 v4, s[40:43], s77 offen  lds
    s_lshl_b32 s12, s33, 14
    s_lshl_b32 s76, s32, 7
    s_add_u32 s12, s12, s76
    s_bfe_u32 s13, s2, 0x20005
    s_waitcnt vmcnt(20)
    s_barrier
    s_add_u32 s77, s30, 3
    s_and_b32 s77, s77, 7
    s_lshl_b32 s74, s77, 7
    s_add_u32 s74, s74, s72
    s_mul_i32 s75, s77, s73
    s_add_u32 m0, s70, 49152
    s_add_u32 s77, s74, 0
    buffer_load_dwordx4 v2, s[36:39], s77 offen  lds
    s_add_u32 m0, s70, 50176
    s_add_u32 s77, s74, 8192
    buffer_load_dwordx4 v3, s[36:39], s77 offen  lds
    s_add_u32 m0, s70, 51200
    s_add_u32 s77, s74, 16384
    buffer_load_dwordx4 v2, s[36:39], s77 offen  lds
    s_add_u32 m0, s70, 52224
    s_add_u32 s77, s74, 24576
    buffer_load_dwordx4 v3, s[36:39], s77 offen  lds
    s_add_u32 m0, s70, 53248
    s_add_u32 s77, s74, 32768
    buffer_load_dwordx4 v2, s[36:39], s77 offen  lds
    s_add_u32 m0, s70, 54272
    s_add_u32 s77, s74, 40960
    buffer_load_dwordx4 v3, s[36:39], s77 offen  lds
    s_add_u32 m0, s70, 55296
    s_add_u32 s77, s74, 49152
    buffer_load_dwordx4 v2, s[36:39], s77 offen  lds
    s_add_u32 m0, s70, 56320
    s_add_u32 s77, s74, 57344
    buffer_load_dwordx4 v3, s[36:39], s77 offen  lds
    s_add_u32 m0, s71, 114688
    s_add_u32 s77, s75, s56
    buffer_load_dwordx4 v4, s[40:43], s77 offen  lds
    s_add_u32 m0, s71, 122880
    s_add_u32 s77, s75, s60
    buffer_load_dwordx4 v4, s[40:43], s77 offen  lds
    s_add_u32 m0, s71, 115712
    s_add_u32 s77, s75, s57
    buffer_load_dwordx4 v4, s[40:43], s77 offen  lds
    s_add_u32 m0, s71, 123904
    s_add_u32 s77, s75, s61
    buffer_load_dwordx4 v4, s[40:43], s77 offen  lds
    s_add_u32 m0, s71, 116736
    s_add_u32 s77, s75, s58
    buffer_load_dwordx4 v4, s[40:43], s77 offen  lds
    s_add_u32 m0, s71, 124928
    s_add_u32 s77, s75, s62
    buffer_load_dwordx4 v4, s[40:43], s77 offen  lds
    s_add_u32 m0, s71, 117760
    s_add_u32 s77, s75, s59
    buffer_load_dwordx4 v4, s[40:43], s77 offen  lds
    s_add_u32 m0, s71, 125952
    s_add_u32 s77, s75, s63
    buffer_load_dwordx4 v4, s[40:43], s77 offen  lds
    s_waitcnt vmcnt(16)
    s_barrier
    s_add_u32 s77, s30, 4
    s_and_b32 s77, s77, 7
    s_lshl_b32 s74, s77, 7
    s_add_u32 s74, s74, s72
    s_mul_i32 s75, s77, s73
    s_add_u32 m0, s70, 0
    s_add_u32 s77, s74, 0
    buffer_load_dwordx4 v2, s[36:39], s77 offen  lds
    s_add_u32 m0, s70, 1024
    s_add_u32 s77, s74, 8192
    buffer_load_dwordx4 v3, s[36:39], s77 offen  lds
    s_add_u32 m0, s70, 2048
    s_add_u32 s77, s74, 16384
    buffer_load_dwordx4 v2, s[36:39], s77 offen  lds
    s_add_u32 m0, s70, 3072
    s_add_u32 s77, s74, 24576
    buffer_load_dwordx4 v3, s[36:39], s77 offen  lds
    s_add_u32 m0, s70, 4096
    s_add_u32 s77, s74, 32768
    buffer_load_dwordx4 v2, s[36:39], s77 offen  lds
    s_add_u32 m0, s70, 5120
    s_add_u32 s77, s74, 40960
    buffer_load_dwordx4 v3, s[36:39], s77 offen  lds
    s_add_u32 m0, s70, 6144
    s_add_u32 s77, s74, 49152
    buffer_load_dwordx4 v2, s[36:39], s77 offen  lds
    s_add_u32 m0, s70, 7168
    s_add_u32 s77, s74, 57344
    buffer_load_dwordx4 v3, s[36:39], s77 offen  lds
    s_add_u32 m0, s71, 65536
    s_add_u32 s77, s75, s56
    buffer_load_dwordx4 v4, s[40:43], s77 offen  lds
    s_add_u32 m0, s71, 73728
    s_add_u32 s77, s75, s60
    buffer_load_dwordx4 v4, s[40:43], s77 offen  lds
    s_add_u32 m0, s71, 66560
    s_add_u32 s77, s75, s57
    buffer_load_dwordx4 v4, s[40:43], s77 offen  lds
    s_add_u32 m0, s71, 74752
    s_add_u32 s77, s75, s61
    buffer_load_dwordx4 v4, s[40:43], s77 offen  lds
    s_add_u32 m0, s71, 67584
    s_add_u32 s77, s75, s58
    buffer_load_dwordx4 v4, s[40:43], s77 offen  lds
    s_add_u32 m0, s71, 75776
    s_add_u32 s77, s75, s62
    buffer_load_dwordx4 v4, s[40:43], s77 offen  lds
    s_add_u32 m0, s71, 68608
    s_add_u32 s77, s75, s59
    buffer_load_dwordx4 v4, s[40:43], s77 offen  lds
    s_add_u32 m0, s71, 76800
    s_add_u32 s77, s75, s63
    buffer_load_dwordx4 v4, s[40:43], s77 offen  lds
    s_waitcnt vmcnt(16)
    s_barrier
    s_add_u32 s77, s30, 5
    s_and_b32 s77, s77, 7
    s_lshl_b32 s74, s77, 7
    s_add_u32 s74, s74, s72
    s_mul_i32 s75, s77, s73
    s_add_u32 m0, s70, 16384
    s_add_u32 s77, s74, 0
    buffer_load_dwordx4 v2, s[36:39], s77 offen  lds
    s_add_u32 m0, s70, 17408
    s_add_u32 s77, s74, 8192
    buffer_load_dwordx4 v3, s[36:39], s77 offen  lds
    s_add_u32 m0, s70, 18432
    s_add_u32 s77, s74, 16384
    buffer_load_dwordx4 v2, s[36:39], s77 offen  lds
    s_add_u32 m0, s70, 19456
    s_add_u32 s77, s74, 24576
    buffer_load_dwordx4 v3, s[36:39], s77 offen  lds
    s_add_u32 m0, s70, 20480
    s_add_u32 s77, s74, 32768
    buffer_load_dwordx4 v2, s[36:39], s77 offen  lds
    s_add_u32 m0, s70, 21504
    s_add_u32 s77, s74, 40960
    buffer_load_dwordx4 v3, s[36:39], s77 offen  lds
    s_add_u32 m0, s70, 22528
    s_add_u32 s77, s74, 49152
    buffer_load_dwordx4 v2, s[36:39], s77 offen  lds
    s_add_u32 m0, s70, 23552
    s_add_u32 s77, s74, 57344
    buffer_load_dwordx4 v3, s[36:39], s77 offen  lds
    s_add_u32 m0, s71, 81920
    s_add_u32 s77, s75, s56
    buffer_load_dwordx4 v4, s[40:43], s77 offen  lds
    s_add_u32 m0, s71, 90112
    s_add_u32 s77, s75, s60
    buffer_load_dwordx4 v4, s[40:43], s77 offen  lds
    s_add_u32 m0, s71, 82944
    s_add_u32 s77, s75, s57
    buffer_load_dwordx4 v4, s[40:43], s77 offen  lds
    s_add_u32 m0, s71, 91136
    s_add_u32 s77, s75, s61
    buffer_load_dwordx4 v4, s[40:43], s77 offen  lds
    s_add_u32 m0, s71, 83968
    s_add_u32 s77, s75, s58
    buffer_load_dwordx4 v4, s[40:43], s77 offen  lds
    s_add_u32 m0, s71, 92160
    s_add_u32 s77, s75, s62
    buffer_load_dwordx4 v4, s[40:43], s77 offen  lds
    s_add_u32 m0, s71, 84992
    s_add_u32 s77, s75, s59
    buffer_load_dwordx4 v4, s[40:43], s77 offen  lds
    s_add_u32 m0, s71, 93184
    s_add_u32 s77, s75, s63
    buffer_load_dwordx4 v4, s[40:43], s77 offen  lds
    s_waitcnt vmcnt(16)
    s_barrier
    s_add_u32 s77, s30, 6
    s_and_b32 s77, s77, 7
    s_lshl_b32 s74, s77, 7
    s_add_u32 s74, s74, s72
    s_mul_i32 s75, s77, s73
    s_add_u32 m0, s70, 32768
    s_add_u32 s77, s74, 0
    buffer_load_dwordx4 v2, s[36:39], s77 offen  lds
    s_add_u32 m0, s70, 33792
    s_add_u32 s77, s74, 8192
    buffer_load_dwordx4 v3, s[36:39], s77 offen  lds
    s_add_u32 m0, s70, 34816
    s_add_u32 s77, s74, 16384
    buffer_load_dwordx4 v2, s[36:39], s77 offen  lds
    s_add_u32 m0, s70, 35840
    s_add_u32 s77, s74, 24576
    buffer_load_dwordx4 v3, s[36:39], s77 offen  lds
    s_add_u32 m0, s70, 36864
    s_add_u32 s77, s74, 32768
    buffer_load_dwordx4 v2, s[36:39], s77 offen  lds
    s_add_u32 m0, s70, 37888
    s_add_u32 s77, s74, 40960
    buffer_load_dwordx4 v3, s[36:39], s77 offen  lds
    s_add_u32 m0, s70, 38912
    s_add_u32 s77, s74, 49152
    buffer_load_dwordx4 v2, s[36:39], s77 offen  lds
    s_add_u32 m0, s70, 39936
    s_add_u32 s77, s74, 57344
    buffer_load_dwordx4 v3, s[36:39], s77 offen  lds
    s_add_u32 m0, s71, 98304
    s_add_u32 s77, s75, s56
    buffer_load_dwordx4 v4, s[40:43], s77 offen  lds
    s_add_u32 m0, s71, 106496
    s_add_u32 s77, s75, s60
    buffer_load_dwordx4 v4, s[40:43], s77 offen  lds
    s_add_u32 m0, s71, 99328
    s_add_u32 s77, s75, s57
    buffer_load_dwordx4 v4, s[40:43], s77 offen  lds
    s_add_u32 m0, s71, 107520
    s_add_u32 s77, s75, s61
    buffer_load_dwordx4 v4, s[40:43], s77 offen  lds
    s_add_u32 m0, s71, 100352
    s_add_u32 s77, s75, s58
    buffer_load_dwordx4 v4, s[40:43], s77 offen  lds
    s_add_u32 m0, s71, 108544
    s_add_u32 s77, s75, s62
    buffer_load_dwordx4 v4, s[40:43], s77 offen  lds
    s_add_u32 m0, s71, 101376
    s_add_u32 s77, s75, s59
    buffer_load_dwordx4 v4, s[40:43], s77 offen  lds
    s_add_u32 m0, s71, 109568
    s_add_u32 s77, s75, s63
    buffer_load_dwordx4 v4, s[40:43], s77 offen  lds
    s_waitcnt vmcnt(16)
    s_barrier
    s_add_u32 s77, s30, 7
    s_and_b32 s77, s77, 7
    s_lshl_b32 s74, s77, 7
    s_add_u32 s74, s74, s72
    s_mul_i32 s75, s77, s73
    s_add_u32 m0, s70, 49152
    s_add_u32 s77, s74, 0
    buffer_load_dwordx4 v2, s[36:39], s77 offen  lds
    s_add_u32 m0, s70, 50176
    s_add_u32 s77, s74, 8192
    buffer_load_dwordx4 v3, s[36:39], s77 offen  lds
    s_add_u32 m0, s70, 51200
    s_add_u32 s77, s74, 16384
    buffer_load_dwordx4 v2, s[36:39], s77 offen  lds
    s_add_u32 m0, s70, 52224
    s_add_u32 s77, s74, 24576
    buffer_load_dwordx4 v3, s[36:39], s77 offen  lds
    s_add_u32 m0, s70, 53248
    s_add_u32 s77, s74, 32768
    buffer_load_dwordx4 v2, s[36:39], s77 offen  lds
    s_add_u32 m0, s70, 54272
    s_add_u32 s77, s74, 40960
    buffer_load_dwordx4 v3, s[36:39], s77 offen  lds
    s_add_u32 m0, s70, 55296
    s_add_u32 s77, s74, 49152
    buffer_load_dwordx4 v2, s[36:39], s77 offen  lds
    s_add_u32 m0, s70, 56320
    s_add_u32 s77, s74, 57344
    buffer_load_dwordx4 v3, s[36:39], s77 offen  lds
    s_add_u32 m0, s71, 114688
    s_add_u32 s77, s75, s56
    buffer_load_dwordx4 v4, s[40:43], s77 offen  lds
    s_add_u32 m0, s71, 122880
    s_add_u32 s77, s75, s60
    buffer_load_dwordx4 v4, s[40:43], s77 offen  lds
    s_add_u32 m0, s71, 115712
    s_add_u32 s77, s75, s57
    buffer_load_dwordx4 v4, s[40:43], s77 offen  lds
    s_add_u32 m0, s71, 123904
    s_add_u32 s77, s75, s61
    buffer_load_dwordx4 v4, s[40:43], s77 offen  lds
    s_add_u32 m0, s71, 116736
    s_add_u32 s77, s75, s58
    buffer_load_dwordx4 v4, s[40:43], s77 offen  lds
    s_add_u32 m0, s71, 124928
    s_add_u32 s77, s75, s62
    buffer_load_dwordx4 v4, s[40:43], s77 offen  lds
    s_add_u32 m0, s71, 117760
    s_add_u32 s77, s75, s59
    buffer_load_dwordx4 v4, s[40:43], s77 offen  lds
    s_add_u32 m0, s71, 125952
    s_add_u32 s77, s75, s63
    buffer_load_dwordx4 v4, s[40:43], s77 offen  lds
    s_waitcnt vmcnt(16)
    s_barrier
    s_waitcnt vmcnt(0)
    s_barrier
    s_add_u32 s77, s30, 0
    s_and_b32 s77, s77, 7
    s_lshl_b32 s74, s77, 7
    s_add_u32 s74, s74, s72
    s_mul_i32 s75, s77, s73
    s_add_u32 m0, s71, 0
    s_add_u32 s77, s75, s64
    buffer_load_dwordx4 v5, s[40:43], s77 offen  lds
    s_add_u32 m0, s71, 1024
    s_add_u32 s77, s75, s65
    buffer_load_dwordx4 v5, s[40:43], s77 offen  lds
    s_add_u32 m0, s71, 2048
    s_add_u32 s77, s75, s66
    buffer_load_dwordx4 v5, s[40:43], s77 offen  lds
    s_add_u32 m0, s71, 3072
    s_add_u32 s77, s75, s67
    buffer_load_dwordx4 v5, s[40:43], s77 offen  lds
    s_add_u32 s77, s30, 1
    s_and_b32 s77, s77, 7
    s_lshl_b32 s74, s77, 7
    s_add_u32 s74, s74, s72
    s_mul_i32 s75, s77, s73
    s_add_u32 m0, s71, 8192
    s_add_u32 s77, s75, s64
    buffer_load_dwordx4 v5, s[40:43], s77 offen  lds
    s_add_u32 m0, s71, 9216
    s_add_u32 s77, s75, s65
    buffer_load_dwordx4 v5, s[40:43], s77 offen  lds
    s_add_u32 m0, s71, 10240
    s_add_u32 s77, s75, s66
    buffer_load_dwordx4 v5, s[40:43], s77 offen  lds
    s_add_u32 m0, s71, 11264
    s_add_u32 s77, s75, s67
    buffer_load_dwordx4 v5, s[40:43], s77 offen  lds
    s_add_u32 s77, s30, 2
    s_and_b32 s77, s77, 7
    s_lshl_b32 s74, s77, 7
    s_add_u32 s74, s74, s72
    s_mul_i32 s75, s77, s73
    s_add_u32 m0, s71, 65536
    s_add_u32 s77, s75, s64
    buffer_load_dwordx4 v5, s[40:43], s77 offen  lds
    s_add_u32 m0, s71, 66560
    s_add_u32 s77, s75, s65
    buffer_load_dwordx4 v5, s[40:43], s77 offen  lds
    s_add_u32 m0, s71, 67584
    s_add_u32 s77, s75, s66
    buffer_load_dwordx4 v5, s[40:43], s77 offen  lds
    s_add_u32 m0, s71, 68608
    s_add_u32 s77, s75, s67
    buffer_load_dwordx4 v5, s[40:43], s77 offen  lds
    s_add_u32 s77, s30, 3
    s_and_b32 s77, s77, 7
    s_lshl_b32 s74, s77, 7
    s_add_u32 s74, s74, s72
    s_mul_i32 s75, s77, s73
    s_add_u32 m0, s71, 73728
    s_add_u32 s77, s75, s64
    buffer_load_dwordx4 v5, s[40:43], s77 offen  lds
    s_add_u32 m0, s71, 74752
    s_add_u32 s77, s75, s65
    buffer_load_dwordx4 v5, s[40:43], s77 offen  lds
    s_add_u32 m0, s71, 75776
    s_add_u32 s77, s75, s66
    buffer_load_dwordx4 v5, s[40:43], s77 offen  lds
    s_add_u32 m0, s71, 76800
    s_add_u32 s77, s75, s67
    buffer_load_dwordx4 v5, s[40:43], s77 offen  lds
    s_add_u32 s77, s30, 4
    s_and_b32 s77, s77, 7
    s_lshl_b32 s74, s77, 7
    s_add_u32 s74, s74, s72
    s_mul_i32 s75, s77, s73
    s_add_u32 m0, s71, 16384
    s_add_u32 s77, s75, s64
    buffer_load_dwordx4 v5, s[40:43], s77 offen  lds
    s_add_u32 m0, s71, 17408
    s_add_u32 s77, s75, s65
    buffer_load_dwordx4 v5, s[40:43], s77 offen  lds
    s_add_u32 m0, s71, 18432
    s_add_u32 s77, s75, s66
    buffer_load_dwordx4 v5, s[40:43], s77 offen  lds
    s_add_u32 m0, s71, 19456
    s_add_u32 s77, s75, s67
    buffer_load_dwordx4 v5, s[40:43], s77 offen  lds
    s_add_u32 s77, s30, 5
    s_and_b32 s77, s77, 7
    s_lshl_b32 s74, s77, 7
    s_add_u32 s74, s74, s72
    s_mul_i32 s75, s77, s73
    s_add_u32 m0, s71, 24576
    s_add_u32 s77, s75, s64
    buffer_load_dwordx4 v5, s[40:43], s77 offen  lds
    s_add_u32 m0, s71, 25600
    s_add_u32 s77, s75, s65
    buffer_load_dwordx4 v5, s[40:43], s77 offen  lds
    s_add_u32 m0, s71, 26624
    s_add_u32 s77, s75, s66
    buffer_load_dwordx4 v5, s[40:43], s77 offen  lds
    s_add_u32 m0, s71, 27648
    s_add_u32 s77, s75, s67
    buffer_load_dwordx4 v5, s[40:43], s77 offen  lds
    s_add_u32 s77, s30, 6
    s_and_b32 s77, s77, 7
    s_lshl_b32 s74, s77, 7
    s_add_u32 s74, s74, s72
    s_mul_i32 s75, s77, s73
    s_add_u32 m0, s71, 81920
    s_add_u32 s77, s75, s64
    buffer_load_dwordx4 v5, s[40:43], s77 offen  lds
    s_add_u32 m0, s71, 82944
    s_add_u32 s77, s75, s65
    buffer_load_dwordx4 v5, s[40:43], s77 offen  lds
    s_add_u32 m0, s71, 83968
    s_add_u32 s77, s75, s66
    buffer_load_dwordx4 v5, s[40:43], s77 offen  lds
    s_add_u32 m0, s71, 84992
    s_add_u32 s77, s75, s67
    buffer_load_dwordx4 v5, s[40:43], s77 offen  lds
    s_add_u32 s77, s30, 7
    s_and_b32 s77, s77, 7
    s_lshl_b32 s74, s77, 7
    s_add_u32 s74, s74, s72
    s_mul_i32 s75, s77, s73
    s_add_u32 m0, s71, 90112
    s_add_u32 s77, s75, s64
    buffer_load_dwordx4 v5, s[40:43], s77 offen  lds
    s_add_u32 m0, s71, 91136
    s_add_u32 s77, s75, s65
    buffer_load_dwordx4 v5, s[40:43], s77 offen  lds
    s_add_u32 m0, s71, 92160
    s_add_u32 s77, s75, s66
    buffer_load_dwordx4 v5, s[40:43], s77 offen  lds
    s_add_u32 m0, s71, 93184
    s_add_u32 s77, s75, s67
    buffer_load_dwordx4 v5, s[40:43], s77 offen  lds
    s_lshl_b32 s73, s33, 14
    s_lshl_b32 s76, s32, 7
    s_add_u32 s73, s73, s76
    s_lshl_b32 s71, s33, 11
    v_add_u32 v30, s71, v7
    v_add_u32 v31, 0x10000, v30
    s_waitcnt vmcnt(0)
    v_mov_b32 v60, 10
    s_mov_b64 exec, 1
    ds_write_b32 v28, v60 offset:30720
    s_mov_b64 exec, -1
    s_add_u32 s13, s28, 8
    s_mov_b32 s76, 0
L_sp_1:
    ds_read_b128 v[60:63], v27 offset:30736
    s_waitcnt lgkmcnt(0)
    v_min3_u32 v60, v60, v61, v62
    v_min_u32 v60, v60, v63
    s_nop 0
    v_readfirstlane_b32 s77, v60
    s_add_u32 s76, s76, 1
    s_cmp_ge_u32 s77, s13
    s_cbranch_scc1 L_spd_3
    s_sleep 1
    s_cmp_lt_u32 s76, 400000
    s_cbranch_scc1 L_sp_1
L_spd_3:
    s_add_u32 s76, s3, 0
    s_and_b32 s76, s76, 7
    s_min_u32 s77, s76, 3
    s_mul_i32 s76, s76, 5
    s_add_u32 s76, s76, s77
    s_lshl_b32 s74, s76, 15
    s_add_u32 s74, s74, s73
    s_add_u32 m0, s71, 32768
    s_add_u32 s77, s74, 0
    buffer_load_dwordx4 v6, s[44:47], s77 offen  lds
    s_add_u32 m0, s71, 33792
    s_add_u32 s77, s74, 8192
    buffer_load_dwordx4 v6, s[44:47], s77 offen  lds
    s_add_u32 m0, s71, 36864
    s_add_u32 s77, s74, 32768
    buffer_load_dwordx4 v6, s[44:47], s77 offen  lds
    s_add_u32 m0, s71, 37888
    s_add_u32 s77, s74, 40960
    buffer_load_dwordx4 v6, s[44:47], s77 offen  lds
    s_add_u32 m0, s71, 40960
    s_add_u32 s77, s74, 65536
    buffer_load_dwordx4 v6, s[44:47], s77 offen  lds
    s_add_u32 m0, s71, 41984
    s_add_u32 s77, s74, 73728
    buffer_load_dwordx4 v6, s[44:47], s77 offen  lds
    s_add_u32 m0, s71, 45056
    s_add_u32 s77, s74, 98304
    buffer_load_dwordx4 v6, s[44:47], s77 offen  lds
    s_add_u32 m0, s71, 46080
    s_add_u32 s77, s74, 106496
    buffer_load_dwordx4 v6, s[44:47], s77 offen  lds
    s_add_u32 s76, s3, 1
    s_and_b32 s76, s76, 7
    s_min_u32 s77, s76, 3
    s_mul_i32 s76, s76, 5
    s_add_u32 s76, s76, s77
    s_lshl_b32 s74, s76, 15
    s_add_u32 s74, s74, s73
    s_add_u32 m0, s71, 98304
    s_add_u32 s77, s74, 0
    buffer_load_dwordx4 v6, s[44:47], s77 offen  lds
    s_add_u32 m0, s71, 99328
    s_add_u32 s77, s74, 8192
    buffer_load_dwordx4 v6, s[44:47], s77 offen  lds
    s_add_u32 m0, s71, 102400
    s_add_u32 s77, s74, 32768
    buffer_load_dwordx4 v6, s[44:47], s77 offen  lds
    s_add_u32 m0, s71, 103424
    s_add_u32 s77, s74, 40960
    buffer_load_dwordx4 v6, s[44:47], s77 offen  lds
    s_add_u32 m0, s71, 106496
    s_add_u32 s77, s74, 65536
    buffer_load_dwordx4 v6, s[44:47], s77 offen  lds
    s_add_u32 m0, s71, 107520
    s_add_u32 s77, s74, 73728
    buffer_load_dwordx4 v6, s[44:47], s77 offen  lds
    s_add_u32 m0, s71, 110592
    s_add_u32 s77, s74, 98304
    buffer_load_dwordx4 v6, s[44:47], s77 offen  lds
    s_add_u32 m0, s71, 111616
    s_add_u32 s77, s74, 106496
    buffer_load_dwordx4 v6, s[44:47], s77 offen  lds
    s_add_u32 s76, s3, 2
    s_and_b32 s76, s76, 7
    s_min_u32 s77, s76, 3
    s_mul_i32 s76, s76, 5
    s_add_u32 s76, s76, s77
    s_lshl_b32 s74, s76, 15
    s_add_u32 s74, s74, s73
    s_add_u32 s77, s74, 0
    buffer_load_dwordx4 a[0:3], v6, s[44:47], s77 offen
    s_add_u32 s77, s74, 8192
    buffer_load_dwordx4 a[4:7], v6, s[44:47], s77 offen
    s_add_u32 s77, s74, 32768
    buffer_load_dwordx4 a[8:11], v6, s[44:47], s77 offen
    s_add_u32 s77, s74, 40960
    buffer_load_dwordx4 a[12:15], v6, s[44:47], s77 offen
    s_add_u32 s77, s74, 65536
    buffer_load_dwordx4 a[16:19], v6, s[44:47], s77 offen
    s_add_u32 s77, s74, 73728
    buffer_load_dwordx4 a[20:23], v6, s[44:47], s77 offen
    s_add_u32 s77, s74, 98304
    buffer_load_dwordx4 a[24:27], v6, s[44:47], s77 offen
    s_add_u32 s77, s74, 106496
    buffer_load_dwordx4 a[28:31], v6, s[44:47], s77 offen
    s_add_u32 s76, s3, 3
    s_and_b32 s76, s76, 7
    s_min_u32 s77, s76, 3
    s_mul_i32 s76, s76, 5
    s_add_u32 s76, s76, s77
    s_lshl_b32 s74, s76, 15
    s_add_u32 s74, s74, s73
    s_add_u32 s77, s74, 0
    buffer_load_dwordx4 a[32:35], v6, s[44:47], s77 offen
    s_add_u32 s77, s74, 8192
    buffer_load_dwordx4 a[36:39], v6, s[44:47], s77 offen
    s_add_u32 s77, s74, 32768
    buffer_load_dwordx4 a[40:43], v6, s[44:47], s77 offen
    s_add_u32 s77, s74, 40960
    buffer_load_dwordx4 a[44:47], v6, s[44:47], s77 offen
    s_add_u32 s77, s74, 65536
    buffer_load_dwordx4 a[48:51], v6, s[44:47], s77 offen
    s_add_u32 s77, s74, 73728
    buffer_load_dwordx4 a[52:55], v6, s[44:47], s77 offen
    s_add_u32 s77, s74, 98304
    buffer_load_dwordx4 a[56:59], v6, s[44:47], s77 offen
    s_add_u32 s77, s74, 106496
    buffer_load_dwordx4 a[60:63], v6, s[44:47], s77 offen
    s_add_u32 s76, s3, 4
    s_and_b32 s76, s76, 7
    s_min_u32 s77, s76, 3
    s_mul_i32 s76, s76, 5
    s_add_u32 s76, s76, s77
    s_lshl_b32 s74, s76, 15
    s_add_u32 s74, s74, s73
    s_add_u32 s77, s74, 0
    buffer_load_dwordx4 a[64:67], v6, s[44:47], s77 offen
    s_add_u32 s77, s74, 8192
    buffer_load_dwordx4 a[68:71], v6, s[44:47], s77 offen
    s_add_u32 s77, s74, 32768
    buffer_load_dwordx4 a[72:75], v6, s[44:47], s77 offen
    s_add_u32 s77, s74, 40960
    buffer_load_dwordx4 a[76:79], v6, s[44:47], s77 offen
    s_add_u32 s77, s74, 65536
    buffer_load_dwordx4 a[80:83], v6, s[44:47], s77 offen
    s_add_u32 s77, s74, 73728
    buffer_load_dwordx4 a[84:87], v6, s[44:47], s77 offen
    s_add_u32 s77, s74, 98304
    buffer_load_dwordx4 a[88:91], v6, s[44:47], s77 offen
    s_add_u32 s77, s74, 106496
    buffer_load_dwordx4 a[92:95], v6, s[44:47], s77 offen
    s_add_u32 s76, s3, 5
    s_and_b32 s76, s76, 7
    s_min_u32 s77, s76, 3
    s_mul_i32 s76, s76, 5
    s_add_u32 s76, s76, s77
    s_lshl_b32 s74, s76, 15
    s_add_u32 s74, s74, s73
    s_add_u32 s77, s74, 0
    buffer_load_dwordx4 a[96:99], v6, s[44:47], s77 offen
    s_add_u32 s77, s74, 8192
    buffer_load_dwordx4 a[100:103], v6, s[44:47], s77 offen
    s_add_u32 s77, s74, 32768
    buffer_load_dwordx4 a[104:107], v6, s[44:47], s77 offen
    s_add_u32 s77, s74, 40960
    buffer_load_dwordx4 a[108:111], v6, s[44:47], s77 offen
    s_add_u32 s77, s74, 65536
    buffer_load_dwordx4 a[112:115], v6, s[44:47], s77 offen
    s_add_u32 s77, s74, 73728
    buffer_load_dwordx4 a[116:119], v6, s[44:47], s77 offen
    s_add_u32 s77, s74, 98304
    buffer_load_dwordx4 a[120:123], v6, s[44:47], s77 offen
    s_add_u32 s77, s74, 106496
    buffer_load_dwordx4 a[124:127], v6, s[44:47], s77 offen
    s_add_u32 s76, s3, 6
    s_and_b32 s76, s76, 7
    s_min_u32 s77, s76, 3
    s_mul_i32 s76, s76, 5
    s_add_u32 s76, s76, s77
    s_lshl_b32 s74, s76, 15
    s_add_u32 s74, s74, s73
    s_add_u32 s77, s74, 0
    buffer_load_dwordx4 v[64:67], v6, s[44:47], s77 offen
    s_add_u32 s77, s74, 8192
    buffer_load_dwordx4 v[68:71], v6, s[44:47], s77 offen
    s_add_u32 s77, s74, 32768
    buffer_load_dwordx4 v[72:75], v6, s[44:47], s77 offen
    s_add_u32 s77, s74, 40960
    buffer_load_dwordx4 v[76:79], v6, s[44:47], s77 offen
    s_add_u32 s77, s74, 65536
    buffer_load_dwordx4 v[80:83], v6, s[44:47], s77 offen
    s_add_u32 s77, s74, 73728
    buffer_load_dwordx4 v[84:87], v6, s[44:47], s77 offen
    s_add_u32 s77, s74, 98304
    buffer_load_dwordx4 v[88:91], v6, s[44:47], s77 offen
    s_add_u32 s77, s74, 106496
    buffer_load_dwordx4 v[92:95], v6, s[44:47], s77 offen
    s_add_u32 s76, s3, 7
    s_and_b32 s76, s76, 7
    s_min_u32 s77, s76, 3
    s_mul_i32 s76, s76, 5
    s_add_u32 s76, s76, s77
    s_lshl_b32 s74, s76, 15
    s_add_u32 s74, s74, s73
    s_add_u32 s77, s74, 0
    buffer_load_dwordx4 v[96:99], v6, s[44:47], s77 offen
    s_add_u32 s77, s74, 8192
    buffer_load_dwordx4 v[100:103], v6, s[44:47], s77 offen
    s_add_u32 s77, s74, 32768
    buffer_load_dwordx4 v[104:107], v6, s[44:47], s77 offen
    s_add_u32 s77, s74, 40960
    buffer_load_dwordx4 v[108:111], v6, s[44:47], s77 offen
    s_add_u32 s77, s74, 65536
    buffer_load_dwordx4 v[112:115], v6, s[44:47], s77 offen
    s_add_u32 s77, s74, 73728
    buffer_load_dwordx4 v[116:119], v6, s[44:47], s77 offen
    s_add_u32 s77, s74, 98304
    buffer_load_dwordx4 v[120:123], v6, s[44:47], s77 offen
    s_add_u32 s77, s74, 106496
    buffer_load_dwordx4 v[124:127], v6, s[44:47], s77 offen
    s_and_b32 s13, s31, 3
    s_cmp_eq_u32 s13, 0
    s_cselect_b32 s76, 131072, 0
    s_cmp_eq_u32 s13, 1
    s_cselect_b32 s76, 163840, s76
    s_cmp_eq_u32 s13, 2
    s_cselect_b32 s76, 327680, s76
    s_cmp_eq_u32 s13, 3
    s_cselect_b32 s76, 360448, s76
    s_add_u32 s77, s76, s73
    buffer_load_dwordx4 v[52:55], v6, s[44:47], s77 offen
    s_add_u32 s77, s77, 8192
    buffer_load_dwordx4 v[52:55], v6, s[44:47], s77 offen
    s_cmp_eq_u32 s13, 0
    s_cselect_b32 s76, 524288, 0
    s_cmp_eq_u32 s13, 1
    s_cselect_b32 s76, 557056, s76
    s_cmp_eq_u32 s13, 2
    s_cselect_b32 s76, 720896, s76
    s_cmp_eq_u32 s13, 3
    s_cselect_b32 s76, 884736, s76
    s_add_u32 s77, s76, s73
    buffer_load_dwordx4 v[52:55], v6, s[44:47], s77 offen
    s_add_u32 s77, s77, 8192
    buffer_load_dwordx4 v[52:55], v6, s[44:47], s77 offen
    s_cmp_eq_u32 s13, 0
    s_cselect_b32 s76, 1048576, 0
    s_cmp_eq_u32 s13, 1
    s_cselect_b32 s76, 1212416, s76
    s_cmp_eq_u32 s13, 2
    s_cselect_b32 s76, 1376256, s76
    s_add_u32 s77, s76, s73
    buffer_load_dwordx4 v[52:55], v6, s[44:47], s77 offen
    s_add_u32 s77, s77, 8192
    buffer_load_dwordx4 v[52:55], v6, s[44:47], s77 offen
    s_lshr_b32 s76, s3, 1
    s_add_u32 s76, s76, 0
    s_and_b32 s76, s76, 3
    s_lshl_b32 s74, s76, 17
    s_add_u32 s74, s74, s73
    s_add_u32 s77, s74, 0
    buffer_load_dwordx4 v[52:55], v6, s[48:51], s77 offen
    s_add_u32 s77, s74, 8192
    buffer_load_dwordx4 v[52:55], v6, s[48:51], s77 offen
    s_add_u32 s77, s74, 32768
    buffer_load_dwordx4 v[52:55], v6, s[48:51], s77 offen
    s_add_u32 s77, s74, 40960
    buffer_load_dwordx4 v[52:55], v6, s[48:51], s77 offen
    s_add_u32 s77, s74, 65536
    buffer_load_dwordx4 v[52:55], v6, s[48:51], s77 offen
    s_add_u32 s77, s74, 73728
    buffer_load_dwordx4 v[52:55], v6, s[48:51], s77 offen
    s_add_u32 s77, s74, 98304
    buffer_load_dwordx4 v[52:55], v6, s[48:51], s77 offen
    s_add_u32 s77, s74, 106496
    buffer_load_dwordx4 v[52:55], v6, s[48:51], s77 offen
    s_waitcnt vmcnt(0)
    s_cmp_lg_u32 s28, 0
    s_cbranch_scc1 L_noq_4
    s_mov_b32 s76, 0
L_sp_5:
    ds_read_b32 v60, v27 offset:30760
    s_waitcnt lgkmcnt(0)
    v_readfirstlane_b32 s77, v60
    s_add_u32 s76, s76, 1
    s_cmp_ge_u32 s77, 2
    s_cbranch_scc1 L_spd_7
    s_sleep 1
    s_cmp_lt_u32 s76, 400000
    s_cbranch_scc1 L_sp_5
L_spd_7:
L_noq_4:
    ds_write_b128 v30, a[0:3] offset:49152
    ds_write_b128 v30, a[4:7] offset:50176
    ds_write_b128 v30, a[8:11] offset:53248
    ds_write_b128 v30, a[12:15] offset:54272
    ds_write_b128 v30, a[16:19] offset:57344
    ds_write_b128 v30, a[20:23] offset:58368
    ds_write_b128 v30, a[24:27] offset:61440
    ds_write_b128 v30, a[28:31] offset:62464
    ds_write_b128 v31, a[32:35] offset:49152
    ds_write_b128 v31, a[36:39] offset:50176
    ds_write_b128 v31, a[40:43] offset:53248
    ds_write_b128 v31, a[44:47] offset:54272
    ds_write_b128 v31, a[48:51] offset:57344
    ds_write_b128 v31, a[52:55] offset:58368
    ds_write_b128 v31, a[56:59] offset:61440
    ds_write_b128 v31, a[60:63] offset:62464
    s_waitcnt vmcnt(0)
    v_mov_b32 v60, 11
    s_mov_b64 exec, 1
    ds_write_b32 v28, v60 offset:30720
    s_mov_b64 exec, -1
    s_mov_b32 s76, 0
L_sp_8:
    ds_read_b128 v[60:63], v27 offset:30736
    s_waitcnt lgkmcnt(0)
    v_min3_u32 v60, v60, v61, v62
    v_min_u32 v60, v60, v63
    s_nop 0
    v_readfirstlane_b32 s77, v60
    s_add_u32 s76, s76, 1
    s_cmp_ge_u32 s77, 10
    s_cbranch_scc1 L_spd_10
    s_sleep 1
    s_cmp_lt_u32 s76, 400000
    s_cbranch_scc1 L_sp_8
L_spd_10:
    ds_write_b128 v30, a[64:67] offset:0
    ds_write_b128 v30, a[68:71] offset:1024
    ds_write_b128 v30, a[72:75] offset:4096
    ds_write_b128 v30, a[76:79] offset:5120
    ds_write_b128 v30, a[80:83] offset:8192
    ds_write_b128 v30, a[84:87] offset:9216
    ds_write_b128 v30, a[88:91] offset:12288
    ds_write_b128 v30, a[92:95] offset:13312
    ds_write_b128 v31, a[96:99] offset:0
    ds_write_b128 v31, a[100:103] offset:1024
    ds_write_b128 v31, a[104:107] offset:4096
    ds_write_b128 v31, a[108:111] offset:5120
    ds_write_b128 v31, a[112:115] offset:8192
    ds_write_b128 v31, a[116:119] offset:9216
    ds_write_b128 v31, a[120:123] offset:12288
    ds_write_b128 v31, a[124:127] offset:13312
    s_waitcnt vmcnt(0)
    v_mov_b32 v60, 12
    s_mov_b64 exec, 1
    ds_write_b32 v28, v60 offset:30720
    s_mov_b64 exec, -1
    s_mov_b32 s76, 0
L_sp_11:
    ds_read_b128 v[60:63], v27 offset:30736
    s_waitcnt lgkmcnt(0)
    v_min3_u32 v60, v60, v61, v62
    v_min_u32 v60, v60, v63
    s_nop 0
    v_readfirstlane_b32 s77, v60
    s_add_u32 s76, s76, 1
    s_cmp_ge_u32 s77, 11
    s_cbranch_scc1 L_spd_13
    s_sleep 1
    s_cmp_lt_u32 s76, 400000
    s_cbranch_scc1 L_sp_11
L_spd_13:
    ds_write_b128 v30, v[64:67] offset:16384
    ds_write_b128 v30, v[68:71] offset:17408
    ds_write_b128 v30, v[72:75] offset:20480
    ds_write_b128 v30, v[76:79] offset:21504
    ds_write_b128 v30, v[80:83] offset:24576
    ds_write_b128 v30, v[84:87] offset:25600
    ds_write_b128 v30, v[88:91] offset:28672
    ds_write_b128 v30, v[92:95] offset:29696
    ds_write_b128 v31, v[96:99] offset:16384
    ds_write_b128 v31, v[100:103] offset:17408
    ds_write_b128 v31, v[104:107] offset:20480
    ds_write_b128 v31, v[108:111] offset:21504
    ds_write_b128 v31, v[112:115] offset:24576
    ds_write_b128 v31, v[116:119] offset:25600
    ds_write_b128 v31, v[120:123] offset:28672
    ds_write_b128 v31, v[124:127] offset:29696
    s_waitcnt vmcnt(0)
    v_mov_b32 v60, 13
    s_mov_b64 exec, 1
    ds_write_b32 v28, v60 offset:30720
    s_mov_b64 exec, -1
    v_lshrrev_b32 v10, 3, v0
    v_lshlrev_b32 v10, 10, v10
    v_and_b32 v11, 7, v0
    v_lshl_add_u32 v10, v11, 4, v10
    s_lshl_b32 s76, s31, 16
    s_lshl_b32 s77, s33, 15
    s_add_u32 s76, s76, s77
    s_lshl_b32 s77, s32, 7
    s_add_u32 s74, s76, s77
    s_lshl_b32 s76, s33, 12
    s_add_u32 m0, s76, 139264
    s_add_u32 s77, s74, 0
    buffer_load_dwordx4 v10, s[36:39], s77 offen  lds
    s_add_u32 m0, s76, 140288
    s_add_u32 s77, s74, 8192
    buffer_load_dwordx4 v10, s[36:39], s77 offen  lds
    s_add_u32 m0, s76, 141312
    s_add_u32 s77, s74, 16384
    buffer_load_dwordx4 v10, s[36:39], s77 offen  lds
    s_add_u32 m0, s76, 142336
    s_add_u32 s77, s74, 24576
    buffer_load_dwordx4 v10, s[36:39], s77 offen  lds
    s_mov_b32 s36, s18
    s_mov_b32 s37, s19
    s_mov_b32 s38, 1024
    s_mov_b32 s39, 0x20000
    s_mov_b64 exec, 0xff
    s_mov_b32 m0, 147456
    s_lshl_b32 s77, s32, 7
    buffer_load_dwordx4 v7, s[36:39], s77 offen  lds
    s_mov_b64 exec, -1
    s_waitcnt vmcnt(0)
    s_mov_b32 s76, 0
L_sp_14:
    ds_read_b128 v[60:63], v27 offset:30736
    s_waitcnt lgkmcnt(0)
    v_min3_u32 v60, v60, v61, v62
    v_min_u32 v60, v60, v63
    s_nop 0
    v_readfirstlane_b32 s77, v60
    s_add_u32 s76, s76, 1
    s_cmp_ge_u32 s77, 13
    s_cbranch_scc1 L_spd_16
    s_sleep 1
    s_cmp_lt_u32 s76, 400000
    s_cbranch_scc1 L_sp_14
L_spd_16:
    s_add_u32 m0, s71, 32768
    s_add_u32 s77, s73, 131072
    buffer_load_dwordx4 v6, s[44:47], s77 offen  lds
    s_add_u32 m0, s71, 33792
    s_add_u32 s77, s73, 139264
    buffer_load_dwordx4 v6, s[44:47], s77 offen  lds
    s_add_u32 m0, s71, 36864
    s_add_u32 s77, s73, 163840
    buffer_load_dwordx4 v6, s[44:47], s77 offen  lds
    s_add_u32 m0, s71, 37888
    s_add_u32 s77, s73, 172032
    buffer_load_dwordx4 v6, s[44:47], s77 offen  lds
    s_add_u32 m0, s71, 40960
    s_add_u32 s77, s73, 327680
    buffer_load_dwordx4 v6, s[44:47], s77 offen  lds
    s_add_u32 m0, s71, 41984
    s_add_u32 s77, s73, 335872
    buffer_load_dwordx4 v6, s[44:47], s77 offen  lds
    s_add_u32 m0, s71, 45056
    s_add_u32 s77, s73, 360448
    buffer_load_dwordx4 v6, s[44:47], s77 offen  lds
    s_add_u32 m0, s71, 46080
    s_add_u32 s77, s73, 368640
    buffer_load_dwordx4 v6, s[44:47], s77 offen  lds
    s_add_u32 m0, s71, 98304
    s_add_u32 s77, s73, 524288
    buffer_load_dwordx4 v6, s[44:47], s77 offen  lds
    s_add_u32 m0, s71, 99328
    s_add_u32 s77, s73, 532480
    buffer_load_dwordx4 v6, s[44:47], s77 offen  lds
    s_add_u32 m0, s71, 102400
    s_add_u32 s77, s73, 557056
    buffer_load_dwordx4 v6, s[44:47], s77 offen  lds
    s_add_u32 m0, s71, 103424
    s_add_u32 s77, s73, 565248
    buffer_load_dwordx4 v6, s[44:47], s77 offen  lds
    s_add_u32 m0, s71, 106496
    s_add_u32 s77, s73, 720896
    buffer_load_dwordx4 v6, s[44:47], s77 offen  lds
    s_add_u32 m0, s71, 107520
    s_add_u32 s77, s73, 729088
    buffer_load_dwordx4 v6, s[44:47], s77 offen  lds
    s_add_u32 m0, s71, 110592
    s_add_u32 s77, s73, 884736
    buffer_load_dwordx4 v6, s[44:47], s77 offen  lds
    s_add_u32 m0, s71, 111616
    s_add_u32 s77, s73, 892928
    buffer_load_dwordx4 v6, s[44:47], s77 offen  lds
    s_add_u32 m0, s71, 49152
    s_add_u32 s77, s73, 1048576
    buffer_load_dwordx4 v6, s[44:47], s77 offen  lds
    s_add_u32 m0, s71, 50176
    s_add_u32 s77, s73, 1056768
    buffer_load_dwordx4 v6, s[44:47], s77 offen  lds
    s_add_u32 m0, s71, 53248
    s_add_u32 s77, s73, 1212416
    buffer_load_dwordx4 v6, s[44:47], s77 offen  lds
    s_add_u32 m0, s71, 54272
    s_add_u32 s77, s73, 1220608
    buffer_load_dwordx4 v6, s[44:47], s77 offen  lds
    s_add_u32 m0, s71, 57344
    s_add_u32 s77, s73, 1376256
    buffer_load_dwordx4 v6, s[44:47], s77 offen  lds
    s_add_u32 m0, s71, 58368
    s_add_u32 s77, s73, 1384448
    buffer_load_dwordx4 v6, s[44:47], s77 offen  lds
    s_waitcnt vmcnt(0)
    v_mov_b32 v60, 14
    s_mov_b64 exec, 1
    ds_write_b32 v28, v60 offset:30720
    s_mov_b64 exec, -1
    s_mov_b32 s76, 0
L_sp_17:
    ds_read_b128 v[60:63], v27 offset:30736
    s_waitcnt lgkmcnt(0)
    v_min3_u32 v60, v60, v61, v62
    v_min_u32 v60, v60, v63
    s_nop 0
    v_readfirstlane_b32 s77, v60
    s_add_u32 s76, s76, 1
    s_cmp_ge_u32 s77, 14
    s_cbranch_scc1 L_spd_19
    s_sleep 1
    s_cmp_lt_u32 s76, 400000
    s_cbranch_scc1 L_sp_17
L_spd_19:
    s_lshr_b32 s76, s3, 1
    s_add_u32 s76, s76, 0
    s_and_b32 s76, s76, 3
    s_lshl_b32 s74, s76, 17
    s_add_u32 s74, s74, s73
    s_add_u32 m0, s71, 114688
    s_add_u32 s77, s74, 0
    buffer_load_dwordx4 v6, s[48:51], s77 offen  lds
    s_add_u32 m0, s71, 115712
    s_add_u32 s77, s74, 8192
    buffer_load_dwordx4 v6, s[48:51], s77 offen  lds
    s_add_u32 m0, s71, 118784
    s_add_u32 s77, s74, 32768
    buffer_load_dwordx4 v6, s[48:51], s77 offen  lds
    s_add_u32 m0, s71, 119808
    s_add_u32 s77, s74, 40960
    buffer_load_dwordx4 v6, s[48:51], s77 offen  lds
    s_add_u32 m0, s71, 122880
    s_add_u32 s77, s74, 65536
    buffer_load_dwordx4 v6, s[48:51], s77 offen  lds
    s_add_u32 m0, s71, 123904
    s_add_u32 s77, s74, 73728
    buffer_load_dwordx4 v6, s[48:51], s77 offen  lds
    s_add_u32 m0, s71, 126976
    s_add_u32 s77, s74, 98304
    buffer_load_dwordx4 v6, s[48:51], s77 offen  lds
    s_add_u32 m0, s71, 128000
    s_add_u32 s77, s74, 106496
    buffer_load_dwordx4 v6, s[48:51], s77 offen  lds
    s_lshr_b32 s76, s3, 1
    s_add_u32 s76, s76, 1
    s_and_b32 s76, s76, 3
    s_lshl_b32 s74, s76, 17
    s_add_u32 s74, s74, s73
    s_add_u32 m0, s71, 0
    s_add_u32 s77, s74, 0
    buffer_load_dwordx4 v6, s[48:51], s77 offen  lds
    s_add_u32 m0, s71, 1024
    s_add_u32 s77, s74, 8192
    buffer_load_dwordx4 v6, s[48:51], s77 offen  lds
    s_add_u32 m0, s71, 4096
    s_add_u32 s77, s74, 32768
    buffer_load_dwordx4 v6, s[48:51], s77 offen  lds
    s_add_u32 m0, s71, 5120
    s_add_u32 s77, s74, 40960
    buffer_load_dwordx4 v6, s[48:51], s77 offen  lds
    s_add_u32 m0, s71, 8192
    s_add_u32 s77, s74, 65536
    buffer_load_dwordx4 v6, s[48:51], s77 offen  lds
    s_add_u32 m0, s71, 9216
    s_add_u32 s77, s74, 73728
    buffer_load_dwordx4 v6, s[48:51], s77 offen  lds
    s_add_u32 m0, s71, 12288
    s_add_u32 s77, s74, 98304
    buffer_load_dwordx4 v6, s[48:51], s77 offen  lds
    s_add_u32 m0, s71, 13312
    s_add_u32 s77, s74, 106496
    buffer_load_dwordx4 v6, s[48:51], s77 offen  lds
    s_lshr_b32 s76, s3, 1
    s_add_u32 s76, s76, 2
    s_and_b32 s76, s76, 3
    s_lshl_b32 s74, s76, 17
    s_add_u32 s74, s74, s73
    s_add_u32 m0, s71, 65536
    s_add_u32 s77, s74, 0
    buffer_load_dwordx4 v6, s[48:51], s77 offen  lds
    s_add_u32 m0, s71, 66560
    s_add_u32 s77, s74, 8192
    buffer_load_dwordx4 v6, s[48:51], s77 offen  lds
    s_add_u32 m0, s71, 69632
    s_add_u32 s77, s74, 32768
    buffer_load_dwordx4 v6, s[48:51], s77 offen  lds
    s_add_u32 m0, s71, 70656
    s_add_u32 s77, s74, 40960
    buffer_load_dwordx4 v6, s[48:51], s77 offen  lds
    s_add_u32 m0, s71, 73728
    s_add_u32 s77, s74, 65536
    buffer_load_dwordx4 v6, s[48:51], s77 offen  lds
    s_add_u32 m0, s71, 74752
    s_add_u32 s77, s74, 73728
    buffer_load_dwordx4 v6, s[48:51], s77 offen  lds
    s_add_u32 m0, s71, 77824
    s_add_u32 s77, s74, 98304
    buffer_load_dwordx4 v6, s[48:51], s77 offen  lds
    s_add_u32 m0, s71, 78848
    s_add_u32 s77, s74, 106496
    buffer_load_dwordx4 v6, s[48:51], s77 offen  lds
    s_lshr_b32 s76, s3, 1
    s_add_u32 s76, s76, 3
    s_and_b32 s76, s76, 3
    s_lshl_b32 s74, s76, 17
    s_add_u32 s74, s74, s73
    s_add_u32 m0, s71, 16384
    s_add_u32 s77, s74, 0
    buffer_load_dwordx4 v6, s[48:51], s77 offen  lds
    s_add_u32 m0, s71, 17408
    s_add_u32 s77, s74, 8192
    buffer_load_dwordx4 v6, s[48:51], s77 offen  lds
    s_add_u32 m0, s71, 20480
    s_add_u32 s77, s74, 32768
    buffer_load_dwordx4 v6, s[48:51], s77 offen  lds
    s_add_u32 m0, s71, 21504
    s_add_u32 s77, s74, 40960
    buffer_load_dwordx4 v6, s[48:51], s77 offen  lds
    s_add_u32 m0, s71, 24576
    s_add_u32 s77, s74, 65536
    buffer_load_dwordx4 v6, s[48:51], s77 offen  lds
    s_add_u32 m0, s71, 25600
    s_add_u32 s77, s74, 73728
    buffer_load_dwordx4 v6, s[48:51], s77 offen  lds
    s_add_u32 m0, s71, 28672
    s_add_u32 s77, s74, 98304
    buffer_load_dwordx4 v6, s[48:51], s77 offen  lds
    s_add_u32 m0, s71, 29696
    s_add_u32 s77, s74, 106496
    buffer_load_dwordx4 v6, s[48:51], s77 offen  lds
    s_waitcnt vmcnt(0)
    v_mov_b32 v60, 15
    s_mov_b64 exec, 1
    ds_write_b32 v28, v60 offset:30720
    s_mov_b64 exec, -1
    s_endpgm
L_S:
    s_setprio 1
    s_and_b32 s35, s33, 1
    v_bfe_u32 v10, v0, 2, 2
    v_lshrrev_b32 v11, 5, v0
    v_lshl_add_u32 v11, v11, 3, v10
    v_lshlrev_b32 v11, 7, v11
    v_bfe_u32 v12, v0, 4, 1
    v_lshl_add_u32 v11, v12, 5, v11
    v_and_b32 v12, 3, v0
    v_lshl_add_u32 v11, v12, 3, v11
    v_lshrrev_b32 v10, 1, v10
    v_xor_b32 v10, s35, v10
    v_lshl_add_u32 v30, v10, 6, v11
    v_add_u32 v30, 131072, v30
    v_and_b32 v15, 31, v0
    v_lshrrev_b32 v16, 5, v0
    v_lshlrev_b32 v17, 3, v15
    v_lshl_add_u32 v17, v16, 10, v17
    v_lshlrev_b32 v18, 2, v15
    v_lshl_add_u32 v18, v16, 9, v18
    v_mov_b32 v124, 0
    v_mov_b32 v125, 0
    s_waitcnt lgkmcnt(0)
    s_mov_b32 s56, s8
    s_mov_b32 s57, s9
    s_mov_b32 s58, 16384
    s_mov_b32 s59, 0x20000
    s_mov_b32 s60, s14
    s_mov_b32 s61, s15
    s_mul_i32 s62, s28, 2752
    s_mov_b32 s63, 0x20000
    s_mov_b32 s52, s24
    s_mov_b32 s53, s25
    s_mov_b32 s54, 268435456
    s_mov_b32 s55, 0x20000
    s_load_dword s34, s[24:25], 16384
    s_mov_b32 s44, s16
    s_mov_b32 s45, s17
    s_mov_b32 s46, 1409024
    s_mov_b32 s47, 0x20000
    s_mov_b32 s48, s10
    s_mov_b32 s49, s11
    s_mov_b32 s50, 524288
    s_mov_b32 s51, 0x20000
    v_lshrrev_b32 v10, 3, v0
    v_and_b32 v11, 7, v0
    v_bfe_u32 v12, v0, 4, 1
    v_lshlrev_b32 v12, 2, v12
    v_xor_b32 v11, v11, v12
    v_lshlrev_b32 v10, 10, v10
    v_lshl_add_u32 v6, v11, 4, v10
    v_lshlrev_b32 v7, 4, v0
    v_lshlrev_b32 v8, 2, v0
    s_lshl_b32 s76, s33, 2
    s_add_u32 s76, s76, 131072
    v_mov_b32 v28, s76
    v_mov_b32 v27, 131072
    v_mov_b32 v20, 0
    s_lshl_b32 s77, s29, 11
    s_lshl_b32 s76, s35, 10
    s_add_u32 s77, s77, s76
    buffer_load_dwordx4 v[104:107], v7, s[56:59], s77 offen
    s_min_u32 s76, s29, 3
    s_mul_i32 s77, s29, 5
    s_add_u32 s76, s76, s77
    s_lshl_b32 s76, s76, 6
    v_lshlrev_b32 v10, 1, v15
    s_lshl_b32 s77, s35, 7
    s_add_u32 s77, s77, s76
    buffer_load_ushort v108, v10, s[60:63], s77 offen
    buffer_load_ushort v109, v10, s[60:63], s77 offen offset:64
    s_lshl_b32 s77, s35, 6
    s_add_u32 s77, s77, s76
    buffer_load_ushort v110, v10, s[60:63], s77 offen offset:256
    s_lshl_b32 s4, s27, 1
    s_add_u32 s4, s4, s35
    s_lshl_b32 s7, s4, 7
    s_add_u32 s7, s7, 20480
    s_lshl_b32 s4, s4, 12
    s_add_u32 s4, s4, 655360
    s_lshl_b32 s5, s28, 3
    s_add_u32 s5, s5, s29
    s_lshl_b32 s8, s5, 1
    s_add_u32 s8, s8, s35
    s_lshl_b32 s8, s8, 7
    s_add_u32 s8, s8, 36864
    s_mul_i32 s5, s5, 6144
    s_add_u32 s5, s5, 917504
    s_lshl_b32 s77, s35, 10
    s_add_u32 s6, s5, s77
    s_add_u32 s6, s6, 4096
    s_lshl_b32 s77, s35, 11
    s_add_u32 s5, s5, s77
    s_mov_b32 s9, 0x3f803f80
    v_and_b32 v19, 7, v0
    v_lshlrev_b32 v19, 2, v19
    v_mov_b32 v9, s7
    v_mov_b32 v10, s8
    v_and_b32 v11, 8, v0
    v_and_b32 v11, 24, v0
    v_cmp_eq_u32 vcc, 0, v11
    v_and_b32 v11, 16, v0
    v_lshl_add_u32 v10, v11, 1, v10
    v_cndmask_b32 v9, v10, v9, vcc
    v_add_u32 v19, v19, v9
    s_lshl_b32 s13, s27, 7
    s_add_u32 s13, s13, 40960
    v_and_b32 v10, 15, v0
    v_lshlrev_b32 v10, 2, v10
    v_add_u32 v10, s13, v10
    s_mov_b32 s76, 0
    s_mov_b32 s77, -1
    v_cndmask_b32 v19, v19, v10, s[76:77]
    s_getreg_b32 s12, hwreg(HW_REG_XCC_ID)
    s_and_b32 s12, s12, 15
    s_lshl_b32 s12, s12, 24
    v_lshlrev_b32 v31, 3, v0
    s_lshl_b32 s74, s35, 10
    s_add_u32 s74, s74, 131072
    v_add_u32 v2, s74, v31
    s_lshl_b32 s74, s35, 9
    s_add_u32 s74, s74, 131072
    v_add_u32 v3, s74, v8
    v_add_u32 v4, s74, v31
    v_bfe_u32 v10, v0, 2, 2
    v_lshl_add_u32 v10, v16, 2, v10
    v_lshlrev_b32 v10, 5, v10
    v_bfe_u32 v11, v0, 4, 1
    v_lshl_add_u32 v10, v11, 4, v10
    v_bfe_u32 v11, v0, 1, 1
    v_lshl_add_u32 v10, v11, 3, v10
    s_lshl_b32 s76, s35, 10
    s_add_u32 s76, s76, 139264
    v_add_u32 v96, s76, v10
    v_add_u32 v97, s76, v7
    v_bfe_u32 v98, v0, 2, 1
    s_mov_b32 s76, 0x80008000
    v_mul_lo_u32 v98, v98, s76
    s_lshl_b32 s76, s35, 11
    s_add_u32 s76, s76, 157696
    v_add_u32 v99, s76, v7
    v_mov_b32 v100, s9
    v_mov_b32 v101, s9
    v_mov_b32 v102, s9
    v_mov_b32 v103, s9
    v_bfe_u32 v12, v0, 2, 2
    v_lshrrev_b32 v13, 5, v0
    v_lshl_add_u32 v15, v13, 3, v12
    v_and_b32 v13, 1, v0
    v_bfe_u32 v14, v0, 1, 1
    v_bfe_u32 v16, v0, 4, 1
    v_lshl_add_u32 v5, v13, 1, v16
    v_lshrrev_b32 v12, 1, v12
    v_xor_b32 v5, v5, v12
    v_lshlrev_b32 v22, 6, v15
    v_lshl_add_u32 v22, v5, 4, v22
    v_lshl_add_u32 v22, v14, 3, v22
    s_mul_i32 s76, s35, 65536
    s_add_u32 s76, s76, 49152
    v_add_u32 v22, s76, v22
    v_lshlrev_b32 v24, 4, v13
    v_lshl_add_u32 v24, v14, 3, v24
    s_lshl_b32 s76, s35, 6
    v_add_u32 v24, s76, v24
    v_add_u32 v29, 32, v24
    v_cmp_eq_u32 vcc, 1, v16
    v_mov_b32 v13, 128
    v_xor_b32 v23, 32, v22
    v_cndmask_b32 v24, v24, v13, vcc
    v_cndmask_b32 v29, v29, v13, vcc
    v_mul_u32_u24 v12, 144, v15
    v_add_u32 v12, 131072, v12
    v_add_u32 v24, v24, v12
    v_add_u32 v29, v29, v12
    s_mul_i32 s76, s27, 960
    s_sub_u32 s76, 16384, s76
    v_lshrrev_b32 v12, 5, v0
    v_lshlrev_b32 v12, 5, v12
    v_add_u32 v12, s76, v12
    v_add_u32 v13, 16, v12
    v_add_u32 v14, 256, v7
    v_cndmask_b32 v25, v7, v12, vcc
    v_cndmask_b32 v26, v14, v13, vcc
    s_lshl_b32 s76, s29, 1
    s_add_u32 s76, s76, s35
    s_lshl_b32 s10, s76, 8
    s_add_u32 s10, s10, 8192
    s_mul_i32 s11, s76, 34816
    s_add_u32 s11, s11, 65536
    v_and_b32 v11, 15, v0
    v_lshlrev_b32 v11, 2, v11
    v_lshl_add_u32 v11, v16, 7, v11
    s_lshl_b32 s76, s35, 11
    s_add_u32 s76, s76, 131072
    v_add_u32 v5, s76, v7
    v_and_b32 v12, 3, v0
    v_lshlrev_b32 v12, 4, v12
    v_lshrrev_b32 v14, 5, v0
    v_lshl_add_u32 v12, v14, 3, v12
    s_lshl_b32 s76, s35, 7
    s_add_u32 s76, s76, 135168
    v_add_u32 v6, s76, v12
    s_barrier
    s_waitcnt vmcnt(3)
    ds_write_b128 v97, v[104:107]
    ds_read_b64_tr_b16 v[32:33], v96 offset:0
    ds_read_b64_tr_b16 v[34:35], v96 offset:256
    ds_read_b64_tr_b16 v[36:37], v96 offset:512
    ds_read_b64_tr_b16 v[38:39], v96 offset:768
    s_waitcnt lgkmcnt(0)
    s_add_u32 s34, s34, 1
    v_xor_b32 v32, v98, v32
    v_xor_b32 v33, v98, v33
    v_xor_b32 v34, v98, v34
    v_xor_b32 v35, v98, v35
    v_xor_b32 v36, v98, v36
    v_xor_b32 v37, v98, v37
    v_xor_b32 v38, v98, v38
    v_xor_b32 v39, v98, v39
    ds_write_b128 v99, v[32:35]
    ds_write_b128 v99, v[36:39] offset:1024
    v_mov_b32 v21, s34
    s_xor_b32 s12, s12, s34
    v_mov_b32 v111, s12
    s_lshl_b32 s76, s28, 5
    s_add_u32 s13, s13, s76
    s_lshl_b32 s76, s29, 2
    s_add_u32 s13, s13, s76
    s_mov_b64 exec, 1
    buffer_store_dword v111, v20, s[52:55], s13 offen sc1
    s_mov_b64 exec, -1
    s_mov_b32 s76, 0
L_sp_20:
    ds_read_b32 v60, v27 offset:30768
    s_waitcnt lgkmcnt(0)
    v_readfirstlane_b32 s77, v60
    s_add_u32 s76, s76, 1
    s_cmp_ge_u32 s77, 4
    s_cbranch_scc1 L_spd_22
    s_cmp_lt_u32 s76, 400000
    s_cbranch_scc1 L_sp_20
L_spd_22:
    ds_read_b64 v[112:113], v2 offset:18432
    ds_read_b64 v[116:117], v2 offset:18944
    ds_read_b32 v120, v3 offset:20480
    ds_read_b32 v122, v3 offset:20736
    s_lshl_b32 s76, s30, 8
    s_add_u32 s76, s76, s4
    s_lshl_b32 s77, s30, 7
    s_add_u32 s77, s77, s5
    s_waitcnt lgkmcnt(0)
    s_mov_b64 exec, 0xffffffff
    buffer_store_dwordx2 v[112:113], v17, s[52:55], s76 offen sc1
    buffer_store_dwordx2 v[116:117], v17, s[52:55], s76 offen offset:2048 sc1
    buffer_store_dword v120, v18, s[52:55], s77 offen sc1
    buffer_store_dword v122, v18, s[52:55], s77 offen offset:1024 sc1
    s_mov_b64 exec, -1
    s_barrier
    ds_read_b64_tr_b16 v[32:33], v30 offset:0
    ds_read_b64_tr_b16 v[34:35], v30 offset:512
    ds_read_b64_tr_b16 v[36:37], v30 offset:2048
    ds_read_b64_tr_b16 v[38:39], v30 offset:2560
    ds_read_b64_tr_b16 v[40:41], v30 offset:4096
    ds_read_b64_tr_b16 v[42:43], v30 offset:4608
    ds_read_b64_tr_b16 v[44:45], v30 offset:6144
    ds_read_b64_tr_b16 v[46:47], v30 offset:6656
    s_waitcnt lgkmcnt(6)
    v_mfma_f32_32x32x16_bf16 v[64:79], v[100:103], v[32:35], 0
    s_waitcnt lgkmcnt(4)
    v_mfma_f32_32x32x16_bf16 v[64:79], v[100:103], v[36:39], v[64:79]
    s_waitcnt lgkmcnt(2)
    v_mfma_f32_32x32x16_bf16 v[64:79], v[100:103], v[40:43], v[64:79]
    s_waitcnt lgkmcnt(0)
    v_mfma_f32_32x32x16_bf16 v[64:79], v[100:103], v[44:47], v[64:79]
    s_barrier
    s_lshl_b32 s77, s30, 7
    s_add_u32 s77, s77, s6
    s_nop 8
    s_mov_b64 exec, 0xffffffff
    buffer_store_dword v64, v18, s[52:55], s77 offen sc1
    s_mov_b64 exec, -1
    s_waitcnt vmcnt(1)
    s_lshl_b32 s76, s30, 2
    s_add_u32 s77, s76, s7
    s_add_u32 s76, s76, s8
    s_mov_b64 exec, 1
    buffer_store_dword v21, v20, s[52:55], s77 offen sc1
    buffer_store_dword v21, v20, s[52:55], s76 offen sc1
    s_mov_b64 exec, -1
    s_barrier
    s_waitcnt vmcnt(2)
    s_lshl_b32 s76, s30, 2
    s_add_u32 s76, s76, s8
    s_mov_b64 exec, 1
    buffer_store_dword v21, v20, s[52:55], s76 offen offset:32 sc1
    s_mov_b64 exec, -1
    s_barrier
    s_barrier
    buffer_load_dword v9, v19, s[52:55], 0 offen sc1
    s_barrier
    s_waitcnt vmcnt(0)
    v_cmp_eq_u32 vcc, s34, v9
    v_xor_b32 v10, s34, v9
    s_and_b32 s74, vcc_lo, 0xffffff
    v_and_b32 v10, 0xf0ffffff, v10
    v_cmp_eq_u32 vcc, 0, v10
    s_lshl_b32 s74, s74, 8
    s_and_b32 s74, s74, vcc_hi
    s_cmp_eq_u32 s74, 0xffffff00
    s_cbranch_scc0 L_early_23
    buffer_load_dwordx2 v[32:33], v17, s[52:55], s4 offen offset:0 sc1
    buffer_load_dwordx2 v[34:35], v17, s[52:55], s4 offen offset:256 sc1
    buffer_load_dwordx2 v[36:37], v17, s[52:55], s4 offen offset:512 sc1
    buffer_load_dwordx2 v[38:39], v17, s[52:55], s4 offen offset:768 sc1
    buffer_load_dwordx2 v[40:41], v17, s[52:55], s4 offen offset:2048 sc1
    buffer_load_dwordx2 v[42:43], v17, s[52:55], s4 offen offset:2304 sc1
    buffer_load_dwordx2 v[44:45], v17, s[52:55], s4 offen offset:2560 sc1
    buffer_load_dwordx2 v[46:47], v17, s[52:55], s4 offen offset:2816 sc1
    buffer_load_dword v48, v18, s[52:55], s5 offen offset:0 sc1
    buffer_load_dword v49, v18, s[52:55], s5 offen offset:128 sc1
    buffer_load_dword v50, v18, s[52:55], s5 offen offset:256 sc1
    buffer_load_dword v51, v18, s[52:55], s5 offen offset:384 sc1
    buffer_load_dword v52, v18, s[52:55], s5 offen offset:1024 sc1
    buffer_load_dword v53, v18, s[52:55], s5 offen offset:1152 sc1
    buffer_load_dword v54, v18, s[52:55], s5 offen offset:1280 sc1
    buffer_load_dword v55, v18, s[52:55], s5 offen offset:1408 sc1
    buffer_load_dword v56, v18, s[52:55], s6 offen offset:0 sc1
    buffer_load_dword v57, v18, s[52:55], s6 offen offset:128 sc1
    buffer_load_dword v58, v18, s[52:55], s6 offen offset:256 sc1
    buffer_load_dword v59, v18, s[52:55], s6 offen offset:384 sc1
L_early_23:
    s_barrier
    s_cmp_eq_u32 s74, 0xffffff00
    s_cbranch_scc1 L_late_24
    s_mov_b32 s76, 0
L_poll_25:
    v_cmp_eq_u32 vcc, s34, v9
    v_xor_b32 v10, s34, v9
    s_and_b32 s77, vcc_lo, 0xffffff
    v_and_b32 v10, 0xf0ffffff, v10
    v_cmp_eq_u32 vcc, 0, v10
    s_lshl_b32 s77, s77, 8
    s_and_b32 s77, s77, vcc_hi
    s_cmp_eq_u32 s77, 0xffffff00
    s_cbranch_scc1 L_pdone_26
    s_add_u32 s76, s76, 1
    s_cmp_gt_u32 s76, 100000
    s_cbranch_scc1 L_pdone_26
    s_sleep 4
    buffer_load_dword v9, v19, s[52:55], 0 offen sc1
    s_waitcnt vmcnt(0)
    s_branch L_poll_25
L_pdone_26:
    buffer_load_dwordx2 v[32:33], v17, s[52:55], s4 offen offset:0 sc1
    buffer_load_dwordx2 v[34:35], v17, s[52:55], s4 offen offset:256 sc1
    buffer_load_dwordx2 v[36:37], v17, s[52:55], s4 offen offset:512 sc1
    buffer_load_dwordx2 v[38:39], v17, s[52:55], s4 offen offset:768 sc1
    buffer_load_dwordx2 v[40:41], v17, s[52:55], s4 offen offset:2048 sc1
    buffer_load_dwordx2 v[42:43], v17, s[52:55], s4 offen offset:2304 sc1
    buffer_load_dwordx2 v[44:45], v17, s[52:55], s4 offen offset:2560 sc1
    buffer_load_dwordx2 v[46:47], v17, s[52:55], s4 offen offset:2816 sc1
    buffer_load_dword v48, v18, s[52:55], s5 offen offset:0 sc1
    buffer_load_dword v49, v18, s[52:55], s5 offen offset:128 sc1
    buffer_load_dword v50, v18, s[52:55], s5 offen offset:256 sc1
    buffer_load_dword v51, v18, s[52:55], s5 offen offset:384 sc1
    buffer_load_dword v52, v18, s[52:55], s5 offen offset:1024 sc1
    buffer_load_dword v53, v18, s[52:55], s5 offen offset:1152 sc1
    buffer_load_dword v54, v18, s[52:55], s5 offen offset:1280 sc1
    buffer_load_dword v55, v18, s[52:55], s5 offen offset:1408 sc1
    buffer_load_dword v56, v18, s[52:55], s6 offen offset:0 sc1
    buffer_load_dword v57, v18, s[52:55], s6 offen offset:128 sc1
    buffer_load_dword v58, v18, s[52:55], s6 offen offset:256 sc1
    buffer_load_dword v59, v18, s[52:55], s6 offen offset:384 sc1
L_late_24:
    v_cmp_eq_u32 vcc, s12, v9
    s_and_b32 s76, vcc_hi, 0xffff
    s_cmp_eq_u32 s76, 0xffff
    s_cselect_b32 s13, 1, 0
    s_waitcnt vmcnt(0)
    v_pk_add_f32 v[32:33], v[32:33], v[34:35]
    v_pk_add_f32 v[36:37], v[36:37], v[38:39]
    v_pk_add_f32 v[40:41], v[40:41], v[42:43]
    v_pk_add_f32 v[44:45], v[44:45], v[46:47]
    v_pk_add_f32 v[48:49], v[48:49], v[50:51]
    v_pk_add_f32 v[52:53], v[52:53], v[54:55]
    v_pk_add_f32 v[56:57], v[56:57], v[58:59]
    v_pk_add_f32 v[32:33], v[32:33], v[36:37]
    v_pk_add_f32 v[40:41], v[40:41], v[44:45]
    v_add_f32 v120, v48, v49
    v_add_f32 v122, v52, v53
    v_add_f32 v124, v56, v57
    v_mov_b32 v112, v32
    v_mov_b32 v114, v33
    v_mov_b32 v116, v40
    v_mov_b32 v118, v41
    v_mov_b32 v113, v112
    v_mov_b32 v115, v114
    v_mov_b32 v117, v116
    v_mov_b32 v119, v118
    v_mov_b32 v121, v120
    v_mov_b32 v123, v122
    v_mov_b32 v125, v124
    s_nop 1
    v_permlane32_swap_b32 v112, v113
    v_permlane32_swap_b32 v114, v115
    v_permlane32_swap_b32 v116, v117
    v_permlane32_swap_b32 v118, v119
    v_permlane32_swap_b32 v120, v121
    v_permlane32_swap_b32 v122, v123
    v_permlane32_swap_b32 v124, v125
    s_nop 1
    v_add_f32 v112, v112, v113
    v_add_f32 v114, v114, v115
    v_add_f32 v116, v116, v117
    v_add_f32 v118, v118, v119
    v_add_f32 v120, v120, v121
    v_add_f32 v122, v122, v123
    v_add_f32 v124, v124, v125
    s_mov_b32 s76, 0x3b000000
    v_mul_f32 v112, s76, v112
    v_mul_f32 v114, s76, v114
    v_fma_f32 v114, -v112, v112, v114
    v_max_f32 v114, 0, v114
    v_add_f32 v114, 0x3727c5ac, v114
    v_sqrt_f32 v114, v114
    v_sub_f32 v112, 0, v112
    v_mul_f32 v116, s76, v116
    v_mul_f32 v118, s76, v118
    v_fma_f32 v118, -v116, v116, v118
    v_max_f32 v118, 0, v118
    v_add_f32 v118, 0x3727c5ac, v118
    v_sqrt_f32 v118, v118
    v_sub_f32 v116, 0, v116
    s_mov_b32 s76, 0
    s_mov_b32 s77, -1
    v_rcp_f32 v115, v114
    v_cvt_pk_bf16_f32 v32, v112, v112
    v_and_b32 v33, 0xffff0000, v32
    v_sub_f32 v33, v112, v33
    v_cvt_pk_bf16_f32 v33, v33, v33
    v_cvt_pk_bf16_f32 v34, v114, v114
    v_and_b32 v34, 0xffff0000, v34
    v_sub_f32 v34, v114, v34
    v_cvt_pk_bf16_f32 v34, v114, v34
    v_cndmask_b32 v32, v32, v34, s[76:77]
    v_cndmask_b32 v33, v33, 0, s[76:77]
    ds_write_b64 v2, v[32:33] offset:18432
    ds_write_b32 v3, v115 offset:20480
    v_rcp_f32 v119, v118
    v_cvt_pk_bf16_f32 v36, v116, v116
    v_and_b32 v37, 0xffff0000, v36
    v_sub_f32 v37, v116, v37
    v_cvt_pk_bf16_f32 v37, v37, v37
    v_cvt_pk_bf16_f32 v38, v118, v118
    v_and_b32 v38, 0xffff0000, v38
    v_sub_f32 v38, v118, v38
    v_cvt_pk_bf16_f32 v38, v118, v38
    v_cndmask_b32 v36, v36, v38, s[76:77]
    v_cndmask_b32 v37, v37, 0, s[76:77]
    ds_write_b64 v2, v[36:37] offset:18944
    ds_write_b32 v3, v119 offset:20736
    v_cvt_pk_bf16_f32 v40, v120, v120
    v_and_b32 v40, 0xffff0000, v40
    v_sub_f32 v40, v120, v40
    v_cvt_pk_bf16_f32 v40, v120, v40
    v_lshl_or_b32 v108, v108, 16, v108
    v_cndmask_b32 v41, v40, 0, s[76:77]
    v_cndmask_b32 v40, v40, v108, s[76:77]
    ds_write_b64 v2, v[40:41] offset:21504
    v_cvt_pk_bf16_f32 v42, v122, v122
    v_and_b32 v42, 0xffff0000, v42
    v_sub_f32 v42, v122, v42
    v_cvt_pk_bf16_f32 v42, v122, v42
    v_lshl_or_b32 v109, v109, 16, v109
    v_cndmask_b32 v43, v42, 0, s[76:77]
    v_cndmask_b32 v42, v42, v109, s[76:77]
    ds_write_b64 v2, v[42:43] offset:22016
    v_cvt_pk_bf16_f32 v44, v124, v124
    v_and_b32 v44, 0xffff0000, v44
    v_sub_f32 v44, v124, v44
    v_cvt_pk_bf16_f32 v44, v124, v44
    v_lshl_or_b32 v110, v110, 16, v110
    v_cndmask_b32 v45, v44, 0, s[76:77]
    v_cndmask_b32 v44, v44, v110, s[76:77]
    ds_write_b64 v4, v[44:45] offset:23552
    s_cmp_lg_u32 s35, 0
    s_cbranch_scc1 L_loc_27
    v_mov_b32 v60, s13
    s_mov_b64 exec, 1
    ds_write_b32 v27, v60 offset:30772
    s_mov_b64 exec, -1
L_loc_27:
    v_mov_b32 v60, 1
    s_mov_b64 exec, 1
    ds_add_u32 v27, v60 offset:30752
    s_mov_b64 exec, -1
    s_cmp_lg_u32 s28, 0
    s_cbranch_scc1 L_sffn_28
    v_add_u32 v13, 155648, v7
    ds_read_b128 v[112:115], v13
    ds_read_b128 v[116:119], v13 offset:1024
    s_mov_b32 s76, 0
L_sp_30:
    ds_read_b32 v60, v27 offset:30756
    s_waitcnt lgkmcnt(0)
    v_readfirstlane_b32 s77, v60
    s_add_u32 s76, s76, 1
    s_cmp_ge_u32 s77, 4
    s_cbranch_scc1 L_spd_32
    s_cmp_lt_u32 s76, 400000
    s_cbranch_scc1 L_sp_30
L_spd_32:
    ds_read_b64_tr_b16 v[32:33], v22 offset:0
    ds_read_b64_tr_b16 v[34:35], v23 offset:256
    ds_read_b64_tr_b16 v[36:37], v24 offset:0
    ds_read_b64_tr_b16 v[38:39], v24 offset:576
    ds_read_b64_tr_b16 v[40:41], v22 offset:8192
    ds_read_b64_tr_b16 v[42:43], v23 offset:8448
    ds_read_b64_tr_b16 v[44:45], v29 offset:0
    ds_read_b64_tr_b16 v[46:47], v29 offset:576
    ds_read_b64_tr_b16 v[48:49], v22 offset:1024
    ds_read_b64_tr_b16 v[50:51], v23 offset:1280
    ds_read_b64_tr_b16 v[52:53], v24 offset:2304
    ds_read_b64_tr_b16 v[54:55], v24 offset:2880
    s_waitcnt lgkmcnt(8)
    v_mfma_f32_32x32x16_bf16 v[64:79], v[32:35], v[36:39], 0
    ds_read_b64_tr_b16 v[56:57], v22 offset:9216
    ds_read_b64_tr_b16 v[58:59], v23 offset:9472
    ds_read_b64_tr_b16 v[60:61], v29 offset:2304
    ds_read_b64_tr_b16 v[62:63], v29 offset:2880
    s_waitcnt lgkmcnt(8)
    v_mfma_f32_32x32x16_bf16 v[80:95], v[40:43], v[44:47], 0
    ds_read_b64_tr_b16 v[32:33], v22 offset:2048
    ds_read_b64_tr_b16 v[34:35], v23 offset:2304
    ds_read_b64_tr_b16 v[36:37], v24 offset:4608
    ds_read_b64_tr_b16 v[38:39], v24 offset:5184
    s_waitcnt lgkmcnt(8)
    v_mfma_f32_32x32x16_bf16 v[64:79], v[48:51], v[52:55], v[64:79]
    ds_read_b64_tr_b16 v[40:41], v22 offset:10240
    ds_read_b64_tr_b16 v[42:43], v23 offset:10496
    ds_read_b64_tr_b16 v[44:45], v29 offset:4608
    ds_read_b64_tr_b16 v[46:47], v29 offset:5184
    s_waitcnt lgkmcnt(8)
    v_mfma_f32_32x32x16_bf16 v[80:95], v[56:59], v[60:63], v[80:95]
    ds_read_b64_tr_b16 v[48:49], v22 offset:3072
    ds_read_b64_tr_b16 v[50:51], v23 offset:3328
    ds_read_b64_tr_b16 v[52:53], v24 offset:6912
    ds_read_b64_tr_b16 v[54:55], v24 offset:7488
    s_waitcnt lgkmcnt(8)
    v_mfma_f32_32x32x16_bf16 v[64:79], v[32:35], v[36:39], v[64:79]
    ds_read_b64_tr_b16 v[56:57], v22 offset:11264
    ds_read_b64_tr_b16 v[58:59], v23 offset:11520
    ds_read_b64_tr_b16 v[60:61], v29 offset:6912
    ds_read_b64_tr_b16 v[62:63], v29 offset:7488
    s_waitcnt lgkmcnt(8)
    v_mfma_f32_32x32x16_bf16 v[80:95], v[40:43], v[44:47], v[80:95]
    ds_read_b64_tr_b16 v[32:33], v22 offset:4096
    ds_read_b64_tr_b16 v[34:35], v23 offset:4352
    ds_read_b64_tr_b16 v[36:37], v24 offset:9216
    ds_read_b64_tr_b16 v[38:39], v24 offset:9792
    s_waitcnt lgkmcnt(8)
    v_mfma_f32_32x32x16_bf16 v[64:79], v[48:51], v[52:55], v[64:79]
    ds_read_b64_tr_b16 v[40:41], v22 offset:12288
    ds_read_b64_tr_b16 v[42:43], v23 offset:12544
    ds_read_b64_tr_b16 v[44:45], v29 offset:9216
    ds_read_b64_tr_b16 v[46:47], v29 offset:9792
    s_waitcnt lgkmcnt(8)
    v_mfma_f32_32x32x16_bf16 v[80:95], v[56:59], v[60:63], v[80:95]
    ds_read_b64_tr_b16 v[48:49], v22 offset:5120
    ds_read_b64_tr_b16 v[50:51], v23 offset:5376
    ds_read_b64_tr_b16 v[52:53], v24 offset:11520
    ds_read_b64_tr_b16 v[54:55], v24 offset:12096
    s_waitcnt lgkmcnt(8)
    v_mfma_f32_32x32x16_bf16 v[64:79], v[32:35], v[36:39], v[64:79]
    ds_read_b64_tr_b16 v[56:57], v22 offset:13312
    ds_read_b64_tr_b16 v[58:59], v23 offset:13568
    ds_read_b64_tr_b16 v[60:61], v29 offset:11520
    ds_read_b64_tr_b16 v[62:63], v29 offset:12096
    s_waitcnt lgkmcnt(8)
    v_mfma_f32_32x32x16_bf16 v[80:95], v[40:43], v[44:47], v[80:95]
    ds_read_b64_tr_b16 v[32:33], v22 offset:6144
    ds_read_b64_tr_b16 v[34:35], v23 offset:6400
    ds_read_b64_tr_b16 v[36:37], v24 offset:13824
    ds_read_b64_tr_b16 v[38:39], v24 offset:14400
    s_waitcnt lgkmcnt(8)
    v_mfma_f32_32x32x16_bf16 v[64:79], v[48:51], v[52:55], v[64:79]
    ds_read_b64_tr_b16 v[40:41], v22 offset:14336
    ds_read_b64_tr_b16 v[42:43], v23 offset:14592
    ds_read_b64_tr_b16 v[44:45], v29 offset:13824
    ds_read_b64_tr_b16 v[46:47], v29 offset:14400
    s_waitcnt lgkmcnt(8)
    v_mfma_f32_32x32x16_bf16 v[80:95], v[56:59], v[60:63], v[80:95]
    ds_read_b64_tr_b16 v[48:49], v22 offset:7168
    ds_read_b64_tr_b16 v[50:51], v23 offset:7424
    ds_read_b64_tr_b16 v[52:53], v24 offset:16128
    ds_read_b64_tr_b16 v[54:55], v24 offset:16704
    s_waitcnt lgkmcnt(8)
    v_mfma_f32_32x32x16_bf16 v[64:79], v[32:35], v[36:39], v[64:79]
    ds_read_b64_tr_b16 v[56:57], v22 offset:15360
    ds_read_b64_tr_b16 v[58:59], v23 offset:15616
    ds_read_b64_tr_b16 v[60:61], v29 offset:16128
    ds_read_b64_tr_b16 v[62:63], v29 offset:16704
    s_waitcnt lgkmcnt(8)
    v_mfma_f32_32x32x16_bf16 v[80:95], v[40:43], v[44:47], v[80:95]
    s_waitcnt lgkmcnt(4)
    v_mfma_f32_32x32x16_bf16 v[64:79], v[48:51], v[52:55], v[64:79]
    s_waitcnt lgkmcnt(0)
    v_mfma_f32_32x32x16_bf16 v[80:95], v[56:59], v[60:63], v[80:95]
    v_mov_b32 v60, 1
    s_mov_b64 exec, 1
    ds_add_u32 v27, v60 offset:30760
    s_mov_b64 exec, -1
    s_lshl_b32 s76, s27, 10
    s_add_u32 s76, s76, s11
    s_add_u32 s77, s76, 17408
    s_nop 3
    v_cvt_pk_bf16_f32 v64, v64, v65
    v_cvt_pk_bf16_f32 v65, v66, v67
    v_cvt_pk_bf16_f32 v66, v68, v69
    v_cvt_pk_bf16_f32 v67, v70, v71
    v_cvt_pk_bf16_f32 v68, v72, v73
    v_cvt_pk_bf16_f32 v69, v74, v75
    v_cvt_pk_bf16_f32 v70, v76, v77
    v_cvt_pk_bf16_f32 v71, v78, v79
    s_mov_b32 exec_lo, 0x1ffff
    s_mov_b32 exec_hi, 0x1ffff
    buffer_store_dwordx4 v[64:67], v25, s[52:55], s76 offen sc1
    buffer_store_dwordx4 v[68:71], v26, s[52:55], s76 offen sc1
    s_mov_b64 exec, -1
    v_cvt_pk_bf16_f32 v80, v80, v81
    v_cvt_pk_bf16_f32 v81, v82, v83
    v_cvt_pk_bf16_f32 v82, v84, v85
    v_cvt_pk_bf16_f32 v83, v86, v87
    v_cvt_pk_bf16_f32 v84, v88, v89
    v_cvt_pk_bf16_f32 v85, v90, v91
    v_cvt_pk_bf16_f32 v86, v92, v93
    v_cvt_pk_bf16_f32 v87, v94, v95
    s_mov_b32 exec_lo, 0x1ffff
    s_mov_b32 exec_hi, 0x1ffff
    buffer_store_dwordx4 v[80:83], v25, s[52:55], s77 offen sc1
    buffer_store_dwordx4 v[84:87], v26, s[52:55], s77 offen sc1
    s_mov_b64 exec, -1
    s_lshl_b32 s76, s27, 2
    s_add_u32 s76, s76, s10
    s_waitcnt vmcnt(0)
    s_mov_b64 exec, 1
    buffer_store_dword v21, v20, s[52:55], s76 offen sc1
    buffer_store_dword v21, v20, s[52:55], s76 offen offset:128 sc1
    s_mov_b64 exec, -1
    v_mov_b32 v60, 1
    s_mov_b64 exec, 1
    ds_add_u32 v27, v60 offset:30776
    s_mov_b64 exec, -1
    s_mov_b32 s76, 0
L_sp_33:
    ds_read_b128 v[60:63], v27 offset:30736
    s_waitcnt lgkmcnt(0)
    v_min3_u32 v60, v60, v61, v62
    v_min_u32 v60, v60, v63
    s_nop 0
    v_readfirstlane_b32 s77, v60
    s_add_u32 s76, s76, 1
    s_cmp_ge_u32 s77, 12
    s_cbranch_scc1 L_spd_35
    s_sleep 1
    s_cmp_lt_u32 s76, 400000
    s_cbranch_scc1 L_sp_33
L_spd_35:
    s_mov_b32 s76, 0
L_kvspin_36:
    buffer_load_dword v14, v11, s[52:55], s10 offen sc1
    s_waitcnt vmcnt(0)
    v_cmp_ne_u32 vcc, s34, v14
    s_cbranch_vccz L_kvgo_37
    s_sleep 2
    s_add_u32 s76, s76, 1
    s_cmp_gt_u32 s76, 100000
    s_cbranch_scc0 L_kvspin_36
L_kvgo_37:
    s_add_u32 s76, s11, 0
    buffer_load_dwordx4 a[0:3], v7, s[52:55], s76 offen offset:0 sc1
    buffer_load_dwordx4 a[4:7], v7, s[52:55], s76 offen offset:1024 sc1
    buffer_load_dwordx4 a[8:11], v7, s[52:55], s76 offen offset:2048 sc1
    buffer_load_dwordx4 a[12:15], v7, s[52:55], s76 offen offset:3072 sc1
    s_add_u32 s76, s11, 4096
    buffer_load_dwordx4 a[16:19], v7, s[52:55], s76 offen offset:0 sc1
    buffer_load_dwordx4 a[20:23], v7, s[52:55], s76 offen offset:1024 sc1
    buffer_load_dwordx4 a[24:27], v7, s[52:55], s76 offen offset:2048 sc1
    buffer_load_dwordx4 a[28:31], v7, s[52:55], s76 offen offset:3072 sc1
    s_add_u32 s76, s11, 8192
    buffer_load_dwordx4 a[32:35], v7, s[52:55], s76 offen offset:0 sc1
    buffer_load_dwordx4 a[36:39], v7, s[52:55], s76 offen offset:1024 sc1
    buffer_load_dwordx4 a[40:43], v7, s[52:55], s76 offen offset:2048 sc1
    buffer_load_dwordx4 a[44:47], v7, s[52:55], s76 offen offset:3072 sc1
    s_add_u32 s76, s11, 12288
    buffer_load_dwordx4 a[48:51], v7, s[52:55], s76 offen offset:0 sc1
    buffer_load_dwordx4 a[52:55], v7, s[52:55], s76 offen offset:1024 sc1
    buffer_load_dwordx4 a[56:59], v7, s[52:55], s76 offen offset:2048 sc1
    buffer_load_dwordx4 a[60:63], v7, s[52:55], s76 offen offset:3072 sc1
    s_add_u32 s76, s11, 16384
    buffer_load_dwordx4 v[56:59], v7, s[52:55], s76 offen sc1
    s_add_u32 s76, s11, 17408
    buffer_load_dwordx4 a[64:67], v7, s[52:55], s76 offen offset:0 sc1
    buffer_load_dwordx4 a[68:71], v7, s[52:55], s76 offen offset:1024 sc1
    buffer_load_dwordx4 a[72:75], v7, s[52:55], s76 offen offset:2048 sc1
    buffer_load_dwordx4 a[76:79], v7, s[52:55], s76 offen offset:3072 sc1
    s_add_u32 s76, s11, 21504
    buffer_load_dwordx4 a[80:83], v7, s[52:55], s76 offen offset:0 sc1
    buffer_load_dwordx4 a[84:87], v7, s[52:55], s76 offen offset:1024 sc1
    buffer_load_dwordx4 a[88:91], v7, s[52:55], s76 offen offset:2048 sc1
    buffer_load_dwordx4 a[92:95], v7, s[52:55], s76 offen offset:3072 sc1
    s_add_u32 s76, s11, 25600
    buffer_load_dwordx4 a[96:99], v7, s[52:55], s76 offen offset:0 sc1
    buffer_load_dwordx4 a[100:103], v7, s[52:55], s76 offen offset:1024 sc1
    buffer_load_dwordx4 a[104:107], v7, s[52:55], s76 offen offset:2048 sc1
    buffer_load_dwordx4 a[108:111], v7, s[52:55], s76 offen offset:3072 sc1
    s_add_u32 s76, s11, 29696
    buffer_load_dwordx4 a[112:115], v7, s[52:55], s76 offen offset:0 sc1
    buffer_load_dwordx4 a[116:119], v7, s[52:55], s76 offen offset:1024 sc1
    buffer_load_dwordx4 a[120:123], v7, s[52:55], s76 offen offset:2048 sc1
    buffer_load_dwordx4 a[124:127], v7, s[52:55], s76 offen offset:3072 sc1
    s_add_u32 s76, s11, 33792
    buffer_load_dwordx4 v[60:63], v7, s[52:55], s76 offen sc1
    s_mov_b32 s76, 0
L_sp_38:
    ds_read_b32 v55, v27 offset:30760
    s_waitcnt lgkmcnt(0)
    v_readfirstlane_b32 s77, v55
    s_add_u32 s76, s76, 1
    s_cmp_ge_u32 s77, 2
    s_cbranch_scc1 L_spd_40
    s_sleep 1
    s_cmp_lt_u32 s76, 400000
    s_cbranch_scc1 L_sp_38
L_spd_40:
    s_waitcnt vmcnt(33)
    v_mfma_f32_32x32x16_bf16 v[32:47], v[112:115], a[0:3], 0
    s_waitcnt vmcnt(32)
    v_mfma_f32_32x32x16_bf16 v[32:47], v[112:115], a[4:7], v[32:47]
    s_waitcnt vmcnt(31)
    v_mfma_f32_32x32x16_bf16 v[32:47], v[112:115], a[8:11], v[32:47]
    s_waitcnt vmcnt(30)
    v_mfma_f32_32x32x16_bf16 v[32:47], v[112:115], a[12:15], v[32:47]
    s_waitcnt vmcnt(29)
    v_mfma_f32_32x32x16_bf16 v[32:47], v[112:115], a[16:19], v[32:47]
    s_waitcnt vmcnt(28)
    v_mfma_f32_32x32x16_bf16 v[32:47], v[112:115], a[20:23], v[32:47]
    s_waitcnt vmcnt(27)
    v_mfma_f32_32x32x16_bf16 v[32:47], v[112:115], a[24:27], v[32:47]
    s_waitcnt vmcnt(26)
    v_mfma_f32_32x32x16_bf16 v[32:47], v[112:115], a[28:31], v[32:47]
    s_waitcnt vmcnt(25)
    v_mfma_f32_32x32x16_bf16 v[32:47], v[112:115], a[32:35], v[32:47]
    s_waitcnt vmcnt(24)
    v_mfma_f32_32x32x16_bf16 v[32:47], v[112:115], a[36:39], v[32:47]
    s_waitcnt vmcnt(23)
    v_mfma_f32_32x32x16_bf16 v[32:47], v[112:115], a[40:43], v[32:47]
    s_waitcnt vmcnt(22)
    v_mfma_f32_32x32x16_bf16 v[32:47], v[112:115], a[44:47], v[32:47]
    s_waitcnt vmcnt(21)
    v_mfma_f32_32x32x16_bf16 v[32:47], v[112:115], a[48:51], v[32:47]
    s_waitcnt vmcnt(20)
    v_mfma_f32_32x32x16_bf16 v[32:47], v[112:115], a[52:55], v[32:47]
    s_waitcnt vmcnt(19)
    v_mfma_f32_32x32x16_bf16 v[32:47], v[112:115], a[56:59], v[32:47]
    s_waitcnt vmcnt(18)
    v_mfma_f32_32x32x16_bf16 v[32:47], v[112:115], a[60:63], v[32:47]
    s_waitcnt vmcnt(17)
    v_mfma_f32_32x32x16_bf16 v[64:79], v[116:119], v[56:59], 0
    s_waitcnt vmcnt(16)
    v_mfma_f32_32x32x16_bf16 v[96:111], v[112:115], a[64:67], 0
    s_waitcnt vmcnt(15)
    v_mfma_f32_32x32x16_bf16 v[96:111], v[112:115], a[68:71], v[96:111]
    s_waitcnt vmcnt(14)
    v_mfma_f32_32x32x16_bf16 v[96:111], v[112:115], a[72:75], v[96:111]
    s_waitcnt vmcnt(13)
    v_mfma_f32_32x32x16_bf16 v[96:111], v[112:115], a[76:79], v[96:111]
    s_waitcnt vmcnt(12)
    v_mfma_f32_32x32x16_bf16 v[96:111], v[112:115], a[80:83], v[96:111]
    s_waitcnt vmcnt(11)
    v_mfma_f32_32x32x16_bf16 v[96:111], v[112:115], a[84:87], v[96:111]
    s_waitcnt vmcnt(10)
    v_mfma_f32_32x32x16_bf16 v[96:111], v[112:115], a[88:91], v[96:111]
    s_waitcnt vmcnt(9)
    v_mfma_f32_32x32x16_bf16 v[96:111], v[112:115], a[92:95], v[96:111]
    s_waitcnt vmcnt(8)
    v_mfma_f32_32x32x16_bf16 v[96:111], v[112:115], a[96:99], v[96:111]
    s_waitcnt vmcnt(7)
    v_mfma_f32_32x32x16_bf16 v[96:111], v[112:115], a[100:103], v[96:111]
    s_waitcnt vmcnt(6)
    v_mfma_f32_32x32x16_bf16 v[96:111], v[112:115], a[104:107], v[96:111]
    s_waitcnt vmcnt(5)
    v_mfma_f32_32x32x16_bf16 v[96:111], v[112:115], a[108:111], v[96:111]
    s_waitcnt vmcnt(4)
    v_mfma_f32_32x32x16_bf16 v[96:111], v[112:115], a[112:115], v[96:111]
    s_waitcnt vmcnt(3)
    v_mfma_f32_32x32x16_bf16 v[96:111], v[112:115], a[116:119], v[96:111]
    s_waitcnt vmcnt(2)
    v_mfma_f32_32x32x16_bf16 v[96:111], v[112:115], a[120:123], v[96:111]
    s_waitcnt vmcnt(1)
    v_mfma_f32_32x32x16_bf16 v[96:111], v[112:115], a[124:127], v[96:111]
    s_waitcnt vmcnt(0)
    v_mfma_f32_32x32x16_bf16 v[80:95], v[116:119], v[60:63], 0
    s_nop 1
    v_cvt_pk_bf16_f32 v32, v32, v33
    v_cvt_pk_bf16_f32 v33, v34, v35
    v_cvt_pk_bf16_f32 v34, v36, v37
    v_cvt_pk_bf16_f32 v35, v38, v39
    ds_write_b128 v5, v[32:35] offset:0
    v_add_f32_dpp v64, v64, v64 row_shr:4 row_mask:0xf bank_mask:0xf bound_ctrl:0
    v_add_f32_dpp v65, v65, v65 row_shr:4 row_mask:0xf bank_mask:0xf bound_ctrl:0
    v_add_f32_dpp v66, v66, v66 row_shr:4 row_mask:0xf bank_mask:0xf bound_ctrl:0
    v_add_f32_dpp v67, v67, v67 row_shr:4 row_mask:0xf bank_mask:0xf bound_ctrl:0
    v_add_f32_dpp v64, v64, v64 row_shr:8 row_mask:0xf bank_mask:0xf bound_ctrl:0
    v_add_f32_dpp v65, v65, v65 row_shr:8 row_mask:0xf bank_mask:0xf bound_ctrl:0
    v_add_f32_dpp v66, v66, v66 row_shr:8 row_mask:0xf bank_mask:0xf bound_ctrl:0
    v_add_f32_dpp v67, v67, v67 row_shr:8 row_mask:0xf bank_mask:0xf bound_ctrl:0
    v_mov_b32 v68, v64
    v_mov_b32 v69, v65
    v_mov_b32 v70, v66
    v_mov_b32 v71, v67
    s_nop 1
    v_permlane16_swap_b32 v64, v68
    v_permlane16_swap_b32 v65, v69
    v_permlane16_swap_b32 v66, v70
    v_permlane16_swap_b32 v67, v71
    s_nop 1
    v_add_f32 v64, v64, v68
    v_add_f32 v65, v65, v69
    v_add_f32 v66, v66, v70
    v_add_f32 v67, v67, v71
    v_cvt_pk_bf16_f32 v64, v64, v65
    v_cvt_pk_bf16_f32 v65, v66, v67
    s_mov_b32 exec_lo, 0xf000
    s_mov_b32 exec_hi, 0xf000
    ds_write_b64 v6, v[64:65] offset:0
    s_mov_b64 exec, -1
    s_nop 1
    v_cvt_pk_bf16_f32 v96, v96, v97
    v_cvt_pk_bf16_f32 v97, v98, v99
    v_cvt_pk_bf16_f32 v98, v100, v101
    v_cvt_pk_bf16_f32 v99, v102, v103
    ds_write_b128 v5, v[96:99] offset:1024
    v_add_f32_dpp v80, v80, v80 row_shr:4 row_mask:0xf bank_mask:0xf bound_ctrl:0
    v_add_f32_dpp v81, v81, v81 row_shr:4 row_mask:0xf bank_mask:0xf bound_ctrl:0
    v_add_f32_dpp v82, v82, v82 row_shr:4 row_mask:0xf bank_mask:0xf bound_ctrl:0
    v_add_f32_dpp v83, v83, v83 row_shr:4 row_mask:0xf bank_mask:0xf bound_ctrl:0
    v_add_f32_dpp v80, v80, v80 row_shr:8 row_mask:0xf bank_mask:0xf bound_ctrl:0
    v_add_f32_dpp v81, v81, v81 row_shr:8 row_mask:0xf bank_mask:0xf bound_ctrl:0
    v_add_f32_dpp v82, v82, v82 row_shr:8 row_mask:0xf bank_mask:0xf bound_ctrl:0
    v_add_f32_dpp v83, v83, v83 row_shr:8 row_mask:0xf bank_mask:0xf bound_ctrl:0
    v_mov_b32 v84, v80
    v_mov_b32 v85, v81
    v_mov_b32 v86, v82
    v_mov_b32 v87, v83
    s_nop 1
    v_permlane16_swap_b32 v80, v84
    v_permlane16_swap_b32 v81, v85
    v_permlane16_swap_b32 v82, v86
    v_permlane16_swap_b32 v83, v87
    s_nop 1
    v_add_f32 v80, v80, v84
    v_add_f32 v81, v81, v85
    v_add_f32 v82, v82, v86
    v_add_f32 v83, v83, v87
    v_cvt_pk_bf16_f32 v80, v80, v81
    v_cvt_pk_bf16_f32 v81, v82, v83
    s_mov_b32 exec_lo, 0xf000
    s_mov_b32 exec_hi, 0xf000
    ds_write_b64 v6, v[80:81] offset:64
    s_mov_b64 exec, -1
    v_mov_b32 v60, 1
    s_mov_b64 exec, 1
    ds_add_u32 v27, v60 offset:30764
    s_mov_b64 exec, -1
L_sffn_28:
    s_endpgm
L_C:
    s_getpc_b64 s[40:41]
L_pc:
    s_sub_u32 s40, s40, L_pc-parallel_sum__linear_kernel_hedgehog__dense_activation_squared_relu__prompt_kernel
    s_subb_u32 s41, s41, 0
    s_lshr_b32 s68, s2, 3
    s_lshl_b32 s68, s68, 2
    s_add_u32 s68, s68, s33
    s_mul_i32 s68, s68, 384
    v_mul_u32_u24 v10, 6, v0
    v_and_b32 v10, 0xfffffffc, v10
    v_add_u32 v10, s68, v10
    v_min_u32 v10, L_end-parallel_sum__linear_kernel_hedgehog__dense_activation_squared_relu__prompt_kernel, v10
    global_load_dword v15, v10, s[40:41]
    v_lshlrev_b32 v12, 2, v0
    v_add_u32 v12, 131072, v12
    v_mov_b32 v20, 0
    s_mov_b64 exec, 0xffffffff
    ds_write_b32 v12, v20 offset:30720
    s_mov_b64 exec, -1
    s_waitcnt lgkmcnt(0)
    s_load_dword s34, s[24:25], 16384
    v_lshlrev_b32 v1, 4, v0
    v_and_b32 v23, 31, v0
    v_lshrrev_b32 v25, 5, v0
    v_lshlrev_b32 v25, 2, v25
    v_sub_u32 v24, v23, v25
    v_mov_b32 v26, 0x3f80
    v_mov_b32 v27, 0x3f800000
    v_cmp_eq_u32 vcc, 0, v24
    s_nop 1
    v_cndmask_b32 v32, 0, v26, vcc
    v_cmp_eq_u32 vcc, 1, v24
    s_nop 1
    v_cndmask_b32 v32, v32, v27, vcc
    v_cmp_eq_u32 vcc, 2, v24
    s_nop 1
    v_cndmask_b32 v33, 0, v26, vcc
    v_cmp_eq_u32 vcc, 3, v24
    s_nop 1
    v_cndmask_b32 v33, v33, v27, vcc
    v_cmp_eq_u32 vcc, 8, v24
    s_nop 1
    v_cndmask_b32 v34, 0, v26, vcc
    v_cmp_eq_u32 vcc, 9, v24
    s_nop 1
    v_cndmask_b32 v34, v34, v27, vcc
    v_cmp_eq_u32 vcc, 10, v24
    s_nop 1
    v_cndmask_b32 v35, 0, v26, vcc
    v_cmp_eq_u32 vcc, 11, v24
    s_nop 1
    v_cndmask_b32 v35, v35, v27, vcc
    v_cmp_eq_u32 vcc, 0, v23
    s_nop 1
    v_cndmask_b32 v36, 0, v26, vcc
    v_cmp_eq_u32 vcc, 1, v23
    s_nop 1
    v_cndmask_b32 v36, v36, v27, vcc
    v_cmp_eq_u32 vcc, 2, v23
    s_nop 1
    v_cndmask_b32 v37, 0, v26, vcc
    v_cmp_eq_u32 vcc, 3, v23
    s_nop 1
    v_cndmask_b32 v37, v37, v27, vcc
    v_cmp_eq_u32 vcc, 4, v23
    s_nop 1
    v_cndmask_b32 v38, 0, v26, vcc
    v_cmp_eq_u32 vcc, 5, v23
    s_nop 1
    v_cndmask_b32 v38, v38, v27, vcc
    v_cmp_eq_u32 vcc, 6, v23
    s_nop 1
    v_cndmask_b32 v39, 0, v26, vcc
    v_cmp_eq_u32 vcc, 7, v23
    s_nop 1
    v_cndmask_b32 v39, v39, v27, vcc
    v_add_u32 v23, 131072, v1
    ds_write_b128 v23, v[32:35] offset:24576
    ds_write_b128 v23, v[36:39] offset:25600
    v_and_b32 v10, 31, v0
    v_lshrrev_b32 v11, 5, v0
    v_bfe_u32 v12, v0, 1, 3
    v_xor_b32 v11, v11, v12
    v_lshlrev_b32 v10, 7, v10
    v_lshl_add_u32 v10, v11, 4, v10
    s_lshl_b32 s69, s33, 12
    v_add_u32 v2, s69, v10
    v_xor_b32 v3, 32, v2
    v_xor_b32 v4, 64, v2
    v_xor_b32 v5, 96, v2
    v_bfe_u32 v10, v0, 2, 2
    v_lshrrev_b32 v11, 5, v0
    v_lshl_add_u32 v11, v11, 3, v10
    v_lshlrev_b32 v11, 7, v11
    v_bfe_u32 v12, v0, 4, 1
    v_lshl_add_u32 v11, v12, 5, v11
    v_and_b32 v12, 3, v0
    v_lshl_add_u32 v11, v12, 3, v11
    v_lshrrev_b32 v10, 1, v10
    v_xor_b32 v10, 0, v10
    v_lshl_add_u32 v6, v10, 6, v11
    v_xor_b32 v7, 64, v6
    v_add_u32 v8, 0x10000, v6
    v_add_u32 v9, 0x10000, v7
    v_lshlrev_b32 v22, 3, v0
    v_add_u32 v22, 131072, v22
    v_and_b32 v12, 31, v0
    s_lshl_b32 s68, s33, 5
    v_add_u32 v12, s68, v12
    v_lshrrev_b32 v13, 5, v0
    v_mul_u32_u24 v30, 144, v12
    v_lshl_add_u32 v30, v13, 4, v30
    v_add_u32 v30, 131072, v30
    v_bfe_u32 v14, v0, 1, 2
    v_lshlrev_b32 v13, 1, v13
    v_xor_b32 v13, v13, v14
    v_lshlrev_b32 v31, 6, v12
    v_lshl_add_u32 v31, v13, 4, v31
    v_add_u32 v31, 49152, v31
    v_mov_b32 v10, 131072
    s_lshl_b32 s68, s33, 2
    s_add_u32 s68, s68, 131072
    v_mov_b32 v11, s68
    s_lshl_b32 s68, s33, 9
    v_add_u32 v28, s68, v22
    v_lshlrev_b32 v16, 2, v0
    s_lshl_b32 s68, s33, 8
    s_add_u32 s68, s68, 131072
    v_add_u32 v16, s68, v16
    s_and_b32 s68, s33, 1
    s_lshl_b32 s68, s68, 6
    v_xor_b32 v12, s68, v8
    s_lshr_b32 s68, s33, 1
    s_lshl_b32 s68, s68, 13
    v_add_u32 v12, s68, v12
    v_mov_b32 v96, 0
    v_mov_b32 v97, 0
    v_mov_b32 v98, 0
    v_mov_b32 v99, 0
    v_mov_b32 v100, 0
    v_mov_b32 v101, 0
    s_mov_b32 s67, 0x3f803f80
    s_mov_b32 s52, s24
    s_mov_b32 s53, s25
    s_mov_b32 s54, 268435456
    s_mov_b32 s55, 0x20000
    s_mov_b32 s56, s20
    s_mov_b32 s57, s21
    s_mov_b32 s58, 2097152
    s_mov_b32 s59, 0x20000
    s_mov_b32 s44, s24
    s_mov_b32 s45, s25
    s_mov_b32 s46, 268435456
    s_mov_b32 s47, 0x20000
    s_lshl_b32 s68, s27, 2
    s_add_u32 s68, s68, s33
    s_mul_i32 s70, s68, 122880
    s_add_u32 s70, s70, 2097152
    s_lshl_b32 s71, s68, 7
    s_add_u32 s71, s71, 0
    s_lshl_b32 s68, s31, 1
    s_lshr_b32 s69, s33, 1
    s_add_u32 s68, s68, s69
    s_mul_i32 s72, s68, 122880
    s_and_b32 s69, s33, 1
    s_lshl_b32 s69, s69, 10
    s_add_u32 s72, s72, s69
    s_add_u32 s72, s72, 2097152
    s_lshl_b32 s74, s68, 7
    s_add_u32 s74, s74, 0
    s_waitcnt lgkmcnt(0)
    s_barrier
    ds_read_b128 v[64:67], v2 offset:0
    ds_read_b128 v[68:71], v3 offset:0
    ds_read_b128 v[72:75], v4 offset:0
    ds_read_b128 v[76:79], v5 offset:0
    ds_read_b64_tr_b16 v[80:81], v12 offset:0
    ds_read_b64_tr_b16 v[82:83], v12 offset:512
    ds_read_b64_tr_b16 v[84:85], v12 offset:2048
    ds_read_b64_tr_b16 v[86:87], v12 offset:2560
    ds_read_b64_tr_b16 v[88:89], v12 offset:4096
    ds_read_b64_tr_b16 v[90:91], v12 offset:4608
    ds_read_b64_tr_b16 v[92:93], v12 offset:6144
    ds_read_b64_tr_b16 v[94:95], v12 offset:6656
    s_add_u32 s34, s34, 1
    v_mov_b32 v21, s34
    s_waitcnt lgkmcnt(8)
    v_dot2_f32_bf16 v96, v64, s67, v96
    v_dot2_f32_bf16 v98, v64, v64, v98
    v_dot2_f32_bf16 v97, v65, s67, v97
    v_dot2_f32_bf16 v99, v65, v65, v99
    v_dot2_f32_bf16 v96, v66, s67, v96
    v_dot2_f32_bf16 v98, v66, v66, v98
    v_dot2_f32_bf16 v97, v67, s67, v97
    v_dot2_f32_bf16 v99, v67, v67, v99
    v_dot2_f32_bf16 v96, v68, s67, v96
    v_dot2_f32_bf16 v98, v68, v68, v98
    v_dot2_f32_bf16 v97, v69, s67, v97
    v_dot2_f32_bf16 v99, v69, v69, v99
    v_dot2_f32_bf16 v96, v70, s67, v96
    v_dot2_f32_bf16 v98, v70, v70, v98
    v_dot2_f32_bf16 v97, v71, s67, v97
    v_dot2_f32_bf16 v99, v71, v71, v99
    v_dot2_f32_bf16 v96, v72, s67, v96
    v_dot2_f32_bf16 v98, v72, v72, v98
    v_dot2_f32_bf16 v97, v73, s67, v97
    v_dot2_f32_bf16 v99, v73, v73, v99
    v_dot2_f32_bf16 v96, v74, s67, v96
    v_dot2_f32_bf16 v98, v74, v74, v98
    v_dot2_f32_bf16 v97, v75, s67, v97
    v_dot2_f32_bf16 v99, v75, v75, v99
    v_dot2_f32_bf16 v96, v76, s67, v96
    v_dot2_f32_bf16 v98, v76, v76, v98
    v_dot2_f32_bf16 v97, v77, s67, v97
    v_dot2_f32_bf16 v99, v77, v77, v99
    v_dot2_f32_bf16 v96, v78, s67, v96
    v_dot2_f32_bf16 v98, v78, v78, v98
    v_dot2_f32_bf16 v97, v79, s67, v97
    v_dot2_f32_bf16 v99, v79, v79, v99
    s_waitcnt lgkmcnt(0)
    ds_read_b128 a[0:3], v2 offset:0
    ds_read_b64_tr_b16 v[32:33], v8 offset:0
    ds_read_b64_tr_b16 v[34:35], v8 offset:512
    ds_read_b64_tr_b16 v[36:37], v9 offset:0
    ds_read_b64_tr_b16 v[38:39], v9 offset:512
    ds_read_b64_tr_b16 v[40:41], v8 offset:8192
    ds_read_b64_tr_b16 v[42:43], v8 offset:8704
    ds_read_b64_tr_b16 v[44:45], v9 offset:8192
    ds_read_b64_tr_b16 v[46:47], v9 offset:8704
    v_dot2_f32_bf16 v100, v80, s67, v100
    v_dot2_f32_bf16 v101, v81, s67, v101
    v_dot2_f32_bf16 v100, v82, s67, v100
    v_dot2_f32_bf16 v101, v83, s67, v101
    v_dot2_f32_bf16 v100, v84, s67, v100
    v_dot2_f32_bf16 v101, v85, s67, v101
    v_dot2_f32_bf16 v100, v86, s67, v100
    v_dot2_f32_bf16 v101, v87, s67, v101
    v_dot2_f32_bf16 v100, v88, s67, v100
    v_dot2_f32_bf16 v101, v89, s67, v101
    v_dot2_f32_bf16 v100, v90, s67, v100
    v_dot2_f32_bf16 v101, v91, s67, v101
    v_dot2_f32_bf16 v100, v92, s67, v100
    v_dot2_f32_bf16 v101, v93, s67, v101
    v_dot2_f32_bf16 v100, v94, s67, v100
    v_dot2_f32_bf16 v101, v95, s67, v101
    s_nop 0
    v_add_f32 v96, v96, v97
    v_add_f32 v98, v98, v99
    v_add_f32 v100, v100, v101
    v_mov_b32 v97, v96
    v_mov_b32 v99, v98
    v_mov_b32 v101, v100
    s_nop 1
    v_permlane32_swap_b32 v96, v97
    v_permlane32_swap_b32 v98, v99
    v_permlane32_swap_b32 v100, v101
    s_nop 1
    v_add_f32 v96, v96, v97
    v_add_f32 v97, v98, v99
    v_add_f32 v100, v100, v101
    ds_write_b64 v28, v[96:97] offset:18432
    ds_write_b32 v16, v100 offset:20480
    v_mov_b32 v14, 1
    s_mov_b64 exec, 1
    ds_add_u32 v10, v14 offset:30768
    s_mov_b64 exec, -1
    s_waitcnt lgkmcnt(9)
    v_mfma_f32_32x32x16_bf16 v[64:79], v[32:35], a[0:3], 0
    ds_read_b128 a[4:7], v3 offset:0
    ds_read_b64_tr_b16 v[48:49], v8 offset:2048
    ds_read_b64_tr_b16 v[50:51], v8 offset:2560
    s_waitcnt lgkmcnt(10)
    v_mfma_f32_32x32x16_bf16 v[80:95], v[36:39], a[0:3], 0
    ds_read_b64_tr_b16 v[52:53], v9 offset:2048
    ds_read_b64_tr_b16 v[54:55], v9 offset:2560
    ds_read_b64_tr_b16 v[56:57], v8 offset:10240
    s_waitcnt lgkmcnt(11)
    v_mfma_f32_32x32x16_bf16 v[96:111], v[40:43], a[0:3], 0
    ds_read_b64_tr_b16 v[58:59], v8 offset:10752
    ds_read_b64_tr_b16 v[60:61], v9 offset:10240
    ds_read_b64_tr_b16 v[62:63], v9 offset:10752
    s_waitcnt lgkmcnt(12)
    v_mfma_f32_32x32x16_bf16 v[112:127], v[44:47], a[0:3], 0
    s_waitcnt lgkmcnt(6)
    v_mfma_f32_32x32x16_bf16 v[64:79], v[48:51], a[4:7], v[64:79]
    ds_read_b128 a[8:11], v4 offset:0
    ds_read_b64_tr_b16 v[32:33], v8 offset:4096
    ds_read_b64_tr_b16 v[34:35], v8 offset:4608
    s_waitcnt lgkmcnt(7)
    v_mfma_f32_32x32x16_bf16 v[80:95], v[52:55], a[4:7], v[80:95]
    ds_read_b64_tr_b16 v[36:37], v9 offset:4096
    ds_read_b64_tr_b16 v[38:39], v9 offset:4608
    ds_read_b64_tr_b16 v[40:41], v8 offset:12288
    s_waitcnt lgkmcnt(8)
    v_mfma_f32_32x32x16_bf16 v[96:111], v[56:59], a[4:7], v[96:111]
    ds_read_b64_tr_b16 v[42:43], v8 offset:12800
    ds_read_b64_tr_b16 v[44:45], v9 offset:12288
    ds_read_b64_tr_b16 v[46:47], v9 offset:12800
    s_waitcnt lgkmcnt(9)
    v_mfma_f32_32x32x16_bf16 v[112:127], v[60:63], a[4:7], v[112:127]
    s_waitcnt lgkmcnt(6)
    v_mfma_f32_32x32x16_bf16 v[64:79], v[32:35], a[8:11], v[64:79]
    ds_read_b128 a[12:15], v5 offset:0
    ds_read_b64_tr_b16 v[48:49], v8 offset:6144
    ds_read_b64_tr_b16 v[50:51], v8 offset:6656
    s_waitcnt lgkmcnt(7)
    v_mfma_f32_32x32x16_bf16 v[80:95], v[36:39], a[8:11], v[80:95]
    ds_read_b64_tr_b16 v[52:53], v9 offset:6144
    ds_read_b64_tr_b16 v[54:55], v9 offset:6656
    ds_read_b64_tr_b16 v[56:57], v8 offset:14336
    s_waitcnt lgkmcnt(8)
    v_mfma_f32_32x32x16_bf16 v[96:111], v[40:43], a[8:11], v[96:111]
    ds_read_b64_tr_b16 v[58:59], v8 offset:14848
    ds_read_b64_tr_b16 v[60:61], v9 offset:14336
    ds_read_b64_tr_b16 v[62:63], v9 offset:14848
    s_waitcnt lgkmcnt(9)
    v_mfma_f32_32x32x16_bf16 v[112:127], v[44:47], a[8:11], v[112:127]
    s_waitcnt lgkmcnt(6)
    s_barrier
    v_mfma_f32_32x32x16_bf16 v[64:79], v[48:51], a[12:15], v[64:79]
    ds_read_b128 a[16:19], v2 offset:16384
    ds_read_b64_tr_b16 v[32:33], v8 offset:16384
    ds_read_b64_tr_b16 v[34:35], v8 offset:16896
    s_waitcnt lgkmcnt(7)
    v_mfma_f32_32x32x16_bf16 v[80:95], v[52:55], a[12:15], v[80:95]
    ds_read_b64_tr_b16 v[36:37], v9 offset:16384
    ds_read_b64_tr_b16 v[38:39], v9 offset:16896
    ds_read_b64_tr_b16 v[40:41], v8 offset:24576
    s_waitcnt lgkmcnt(8)
    v_mfma_f32_32x32x16_bf16 v[96:111], v[56:59], a[12:15], v[96:111]
    ds_read_b64_tr_b16 v[42:43], v8 offset:25088
    ds_read_b64_tr_b16 v[44:45], v9 offset:24576
    ds_read_b64_tr_b16 v[46:47], v9 offset:25088
    s_waitcnt lgkmcnt(9)
    v_mfma_f32_32x32x16_bf16 v[112:127], v[60:63], a[12:15], v[112:127]
    s_waitcnt lgkmcnt(6)
    v_mfma_f32_32x32x16_bf16 v[64:79], v[32:35], a[16:19], v[64:79]
    ds_read_b128 a[20:23], v3 offset:16384
    ds_read_b64_tr_b16 v[48:49], v8 offset:18432
    ds_read_b64_tr_b16 v[50:51], v8 offset:18944
    s_waitcnt lgkmcnt(7)
    v_mfma_f32_32x32x16_bf16 v[80:95], v[36:39], a[16:19], v[80:95]
    ds_read_b64_tr_b16 v[52:53], v9 offset:18432
    ds_read_b64_tr_b16 v[54:55], v9 offset:18944
    ds_read_b64_tr_b16 v[56:57], v8 offset:26624
    s_waitcnt lgkmcnt(8)
    v_mfma_f32_32x32x16_bf16 v[96:111], v[40:43], a[16:19], v[96:111]
    ds_read_b64_tr_b16 v[58:59], v8 offset:27136
    ds_read_b64_tr_b16 v[60:61], v9 offset:26624
    ds_read_b64_tr_b16 v[62:63], v9 offset:27136
    s_waitcnt lgkmcnt(9)
    v_mfma_f32_32x32x16_bf16 v[112:127], v[44:47], a[16:19], v[112:127]
    s_waitcnt lgkmcnt(6)
    v_mfma_f32_32x32x16_bf16 v[64:79], v[48:51], a[20:23], v[64:79]
    ds_read_b128 a[24:27], v4 offset:16384
    ds_read_b64_tr_b16 v[32:33], v8 offset:20480
    ds_read_b64_tr_b16 v[34:35], v8 offset:20992
    s_waitcnt lgkmcnt(7)
    v_mfma_f32_32x32x16_bf16 v[80:95], v[52:55], a[20:23], v[80:95]
    ds_read_b64_tr_b16 v[36:37], v9 offset:20480
    ds_read_b64_tr_b16 v[38:39], v9 offset:20992
    ds_read_b64_tr_b16 v[40:41], v8 offset:28672
    s_waitcnt lgkmcnt(8)
    v_mfma_f32_32x32x16_bf16 v[96:111], v[56:59], a[20:23], v[96:111]
    ds_read_b64_tr_b16 v[42:43], v8 offset:29184
    ds_read_b64_tr_b16 v[44:45], v9 offset:28672
    ds_read_b64_tr_b16 v[46:47], v9 offset:29184
    s_waitcnt lgkmcnt(9)
    v_mfma_f32_32x32x16_bf16 v[112:127], v[60:63], a[20:23], v[112:127]
    s_waitcnt lgkmcnt(6)
    v_mfma_f32_32x32x16_bf16 v[64:79], v[32:35], a[24:27], v[64:79]
    ds_read_b128 a[28:31], v5 offset:16384
    ds_read_b64_tr_b16 v[48:49], v8 offset:22528
    ds_read_b64_tr_b16 v[50:51], v8 offset:23040
    s_waitcnt lgkmcnt(7)
    v_mfma_f32_32x32x16_bf16 v[80:95], v[36:39], a[24:27], v[80:95]
    ds_read_b64_tr_b16 v[52:53], v9 offset:22528
    ds_read_b64_tr_b16 v[54:55], v9 offset:23040
    ds_read_b64_tr_b16 v[56:57], v8 offset:30720
    s_waitcnt lgkmcnt(8)
    v_mfma_f32_32x32x16_bf16 v[96:111], v[40:43], a[24:27], v[96:111]
    ds_read_b64_tr_b16 v[58:59], v8 offset:31232
    ds_read_b64_tr_b16 v[60:61], v9 offset:30720
    ds_read_b64_tr_b16 v[62:63], v9 offset:31232
    s_waitcnt lgkmcnt(9)
    v_mfma_f32_32x32x16_bf16 v[112:127], v[44:47], a[24:27], v[112:127]
    s_waitcnt lgkmcnt(6)
    s_barrier
    v_mfma_f32_32x32x16_bf16 v[64:79], v[48:51], a[28:31], v[64:79]
    ds_read_b128 a[32:35], v2 offset:32768
    ds_read_b64_tr_b16 v[32:33], v8 offset:32768
    ds_read_b64_tr_b16 v[34:35], v8 offset:33280
    s_waitcnt lgkmcnt(7)
    v_mfma_f32_32x32x16_bf16 v[80:95], v[52:55], a[28:31], v[80:95]
    ds_read_b64_tr_b16 v[36:37], v9 offset:32768
    ds_read_b64_tr_b16 v[38:39], v9 offset:33280
    ds_read_b64_tr_b16 v[40:41], v8 offset:40960
    s_waitcnt lgkmcnt(8)
    v_mfma_f32_32x32x16_bf16 v[96:111], v[56:59], a[28:31], v[96:111]
    ds_read_b64_tr_b16 v[42:43], v8 offset:41472
    ds_read_b64_tr_b16 v[44:45], v9 offset:40960
    ds_read_b64_tr_b16 v[46:47], v9 offset:41472
    s_waitcnt lgkmcnt(9)
    v_mfma_f32_32x32x16_bf16 v[112:127], v[60:63], a[28:31], v[112:127]
    s_waitcnt lgkmcnt(6)
    v_mfma_f32_32x32x16_bf16 v[64:79], v[32:35], a[32:35], v[64:79]
    ds_read_b128 a[36:39], v3 offset:32768
    ds_read_b64_tr_b16 v[48:49], v8 offset:34816
    ds_read_b64_tr_b16 v[50:51], v8 offset:35328
    s_waitcnt lgkmcnt(7)
    v_mfma_f32_32x32x16_bf16 v[80:95], v[36:39], a[32:35], v[80:95]
    ds_read_b64_tr_b16 v[52:53], v9 offset:34816
    ds_read_b64_tr_b16 v[54:55], v9 offset:35328
    ds_read_b64_tr_b16 v[56:57], v8 offset:43008
    s_waitcnt lgkmcnt(8)
    v_mfma_f32_32x32x16_bf16 v[96:111], v[40:43], a[32:35], v[96:111]
    ds_read_b64_tr_b16 v[58:59], v8 offset:43520
    ds_read_b64_tr_b16 v[60:61], v9 offset:43008
    ds_read_b64_tr_b16 v[62:63], v9 offset:43520
    s_waitcnt lgkmcnt(9)
    v_mfma_f32_32x32x16_bf16 v[112:127], v[44:47], a[32:35], v[112:127]
    s_waitcnt lgkmcnt(6)
    v_mfma_f32_32x32x16_bf16 v[64:79], v[48:51], a[36:39], v[64:79]
    ds_read_b128 a[40:43], v4 offset:32768
    ds_read_b64_tr_b16 v[32:33], v8 offset:36864
    ds_read_b64_tr_b16 v[34:35], v8 offset:37376
    s_waitcnt lgkmcnt(7)
    v_mfma_f32_32x32x16_bf16 v[80:95], v[52:55], a[36:39], v[80:95]
    ds_read_b64_tr_b16 v[36:37], v9 offset:36864
    ds_read_b64_tr_b16 v[38:39], v9 offset:37376
    ds_read_b64_tr_b16 v[40:41], v8 offset:45056
    s_waitcnt lgkmcnt(8)
    v_mfma_f32_32x32x16_bf16 v[96:111], v[56:59], a[36:39], v[96:111]
    ds_read_b64_tr_b16 v[42:43], v8 offset:45568
    ds_read_b64_tr_b16 v[44:45], v9 offset:45056
    ds_read_b64_tr_b16 v[46:47], v9 offset:45568
    s_waitcnt lgkmcnt(9)
    v_mfma_f32_32x32x16_bf16 v[112:127], v[60:63], a[36:39], v[112:127]
    s_waitcnt lgkmcnt(6)
    v_mfma_f32_32x32x16_bf16 v[64:79], v[32:35], a[40:43], v[64:79]
    ds_read_b128 a[44:47], v5 offset:32768
    ds_read_b64_tr_b16 v[48:49], v8 offset:38912
    ds_read_b64_tr_b16 v[50:51], v8 offset:39424
    s_waitcnt lgkmcnt(7)
    v_mfma_f32_32x32x16_bf16 v[80:95], v[36:39], a[40:43], v[80:95]
    ds_read_b64_tr_b16 v[52:53], v9 offset:38912
    ds_read_b64_tr_b16 v[54:55], v9 offset:39424
    ds_read_b64_tr_b16 v[56:57], v8 offset:47104
    s_waitcnt lgkmcnt(8)
    v_mfma_f32_32x32x16_bf16 v[96:111], v[40:43], a[40:43], v[96:111]
    ds_read_b64_tr_b16 v[58:59], v8 offset:47616
    ds_read_b64_tr_b16 v[60:61], v9 offset:47104
    ds_read_b64_tr_b16 v[62:63], v9 offset:47616
    s_waitcnt lgkmcnt(9)
    v_mfma_f32_32x32x16_bf16 v[112:127], v[44:47], a[40:43], v[112:127]
    s_waitcnt lgkmcnt(6)
    s_barrier
    v_mfma_f32_32x32x16_bf16 v[64:79], v[48:51], a[44:47], v[64:79]
    ds_read_b128 a[48:51], v2 offset:49152
    ds_read_b64_tr_b16 v[32:33], v8 offset:49152
    ds_read_b64_tr_b16 v[34:35], v8 offset:49664
    s_waitcnt lgkmcnt(7)
    v_mfma_f32_32x32x16_bf16 v[80:95], v[52:55], a[44:47], v[80:95]
    ds_read_b64_tr_b16 v[36:37], v9 offset:49152
    ds_read_b64_tr_b16 v[38:39], v9 offset:49664
    ds_read_b64_tr_b16 v[40:41], v8 offset:57344
    s_waitcnt lgkmcnt(8)
    v_mfma_f32_32x32x16_bf16 v[96:111], v[56:59], a[44:47], v[96:111]
    ds_read_b64_tr_b16 v[42:43], v8 offset:57856
    ds_read_b64_tr_b16 v[44:45], v9 offset:57344
    ds_read_b64_tr_b16 v[46:47], v9 offset:57856
    s_waitcnt lgkmcnt(9)
    v_mfma_f32_32x32x16_bf16 v[112:127], v[60:63], a[44:47], v[112:127]
    s_waitcnt lgkmcnt(6)
    v_mfma_f32_32x32x16_bf16 v[64:79], v[32:35], a[48:51], v[64:79]
    ds_read_b128 a[52:55], v3 offset:49152
    ds_read_b64_tr_b16 v[48:49], v8 offset:51200
    ds_read_b64_tr_b16 v[50:51], v8 offset:51712
    s_waitcnt lgkmcnt(7)
    v_mfma_f32_32x32x16_bf16 v[80:95], v[36:39], a[48:51], v[80:95]
    ds_read_b64_tr_b16 v[52:53], v9 offset:51200
    ds_read_b64_tr_b16 v[54:55], v9 offset:51712
    ds_read_b64_tr_b16 v[56:57], v8 offset:59392
    s_waitcnt lgkmcnt(8)
    v_mfma_f32_32x32x16_bf16 v[96:111], v[40:43], a[48:51], v[96:111]
    ds_read_b64_tr_b16 v[58:59], v8 offset:59904
    ds_read_b64_tr_b16 v[60:61], v9 offset:59392
    ds_read_b64_tr_b16 v[62:63], v9 offset:59904
    s_waitcnt lgkmcnt(9)
    v_mfma_f32_32x32x16_bf16 v[112:127], v[44:47], a[48:51], v[112:127]
    s_waitcnt lgkmcnt(6)
    v_mfma_f32_32x32x16_bf16 v[64:79], v[48:51], a[52:55], v[64:79]
    ds_read_b128 a[56:59], v4 offset:49152
    ds_read_b64_tr_b16 v[32:33], v8 offset:53248
    ds_read_b64_tr_b16 v[34:35], v8 offset:53760
    s_waitcnt lgkmcnt(7)
    v_mfma_f32_32x32x16_bf16 v[80:95], v[52:55], a[52:55], v[80:95]
    ds_read_b64_tr_b16 v[36:37], v9 offset:53248
    ds_read_b64_tr_b16 v[38:39], v9 offset:53760
    ds_read_b64_tr_b16 v[40:41], v8 offset:61440
    s_waitcnt lgkmcnt(8)
    v_mfma_f32_32x32x16_bf16 v[96:111], v[56:59], a[52:55], v[96:111]
    ds_read_b64_tr_b16 v[42:43], v8 offset:61952
    ds_read_b64_tr_b16 v[44:45], v9 offset:61440
    ds_read_b64_tr_b16 v[46:47], v9 offset:61952
    s_waitcnt lgkmcnt(9)
    v_mfma_f32_32x32x16_bf16 v[112:127], v[60:63], a[52:55], v[112:127]
    s_waitcnt lgkmcnt(6)
    v_mfma_f32_32x32x16_bf16 v[64:79], v[32:35], a[56:59], v[64:79]
    ds_read_b128 a[60:63], v5 offset:49152
    ds_read_b64_tr_b16 v[48:49], v8 offset:55296
    ds_read_b64_tr_b16 v[50:51], v8 offset:55808
    s_waitcnt lgkmcnt(7)
    v_mfma_f32_32x32x16_bf16 v[80:95], v[36:39], a[56:59], v[80:95]
    ds_read_b64_tr_b16 v[52:53], v9 offset:55296
    ds_read_b64_tr_b16 v[54:55], v9 offset:55808
    ds_read_b64_tr_b16 v[56:57], v8 offset:63488
    s_waitcnt lgkmcnt(8)
    v_mfma_f32_32x32x16_bf16 v[96:111], v[40:43], a[56:59], v[96:111]
    ds_read_b64_tr_b16 v[58:59], v8 offset:64000
    ds_read_b64_tr_b16 v[60:61], v9 offset:63488
    ds_read_b64_tr_b16 v[62:63], v9 offset:64000
    s_waitcnt lgkmcnt(9)
    v_mfma_f32_32x32x16_bf16 v[112:127], v[44:47], a[56:59], v[112:127]
    s_waitcnt lgkmcnt(6)
    s_barrier
    v_mfma_f32_32x32x16_bf16 v[64:79], v[48:51], a[60:63], v[64:79]
    ds_read_b128 a[64:67], v2 offset:0
    ds_read_b64_tr_b16 v[32:33], v8 offset:0
    ds_read_b64_tr_b16 v[34:35], v8 offset:512
    s_waitcnt lgkmcnt(7)
    v_mfma_f32_32x32x16_bf16 v[80:95], v[52:55], a[60:63], v[80:95]
    ds_read_b64_tr_b16 v[36:37], v9 offset:0
    ds_read_b64_tr_b16 v[38:39], v9 offset:512
    ds_read_b64_tr_b16 v[40:41], v8 offset:8192
    s_waitcnt lgkmcnt(8)
    v_mfma_f32_32x32x16_bf16 v[96:111], v[56:59], a[60:63], v[96:111]
    ds_read_b64_tr_b16 v[42:43], v8 offset:8704
    ds_read_b64_tr_b16 v[44:45], v9 offset:8192
    ds_read_b64_tr_b16 v[46:47], v9 offset:8704
    s_waitcnt lgkmcnt(9)
    v_mfma_f32_32x32x16_bf16 v[112:127], v[60:63], a[60:63], v[112:127]
    s_waitcnt lgkmcnt(6)
    v_mfma_f32_32x32x16_bf16 v[64:79], v[32:35], a[64:67], v[64:79]
    ds_read_b128 a[68:71], v3 offset:0
    ds_read_b64_tr_b16 v[48:49], v8 offset:2048
    ds_read_b64_tr_b16 v[50:51], v8 offset:2560
    s_waitcnt lgkmcnt(7)
    v_mfma_f32_32x32x16_bf16 v[80:95], v[36:39], a[64:67], v[80:95]
    ds_read_b64_tr_b16 v[52:53], v9 offset:2048
    ds_read_b64_tr_b16 v[54:55], v9 offset:2560
    ds_read_b64_tr_b16 v[56:57], v8 offset:10240
    s_waitcnt lgkmcnt(8)
    v_mfma_f32_32x32x16_bf16 v[96:111], v[40:43], a[64:67], v[96:111]
    ds_read_b64_tr_b16 v[58:59], v8 offset:10752
    ds_read_b64_tr_b16 v[60:61], v9 offset:10240
    ds_read_b64_tr_b16 v[62:63], v9 offset:10752
    s_waitcnt lgkmcnt(9)
    v_mfma_f32_32x32x16_bf16 v[112:127], v[44:47], a[64:67], v[112:127]
    s_waitcnt lgkmcnt(6)
    v_mfma_f32_32x32x16_bf16 v[64:79], v[48:51], a[68:71], v[64:79]
    ds_read_b128 a[72:75], v4 offset:0
    ds_read_b64_tr_b16 v[32:33], v8 offset:4096
    ds_read_b64_tr_b16 v[34:35], v8 offset:4608
    s_waitcnt lgkmcnt(7)
    v_mfma_f32_32x32x16_bf16 v[80:95], v[52:55], a[68:71], v[80:95]
    ds_read_b64_tr_b16 v[36:37], v9 offset:4096
    ds_read_b64_tr_b16 v[38:39], v9 offset:4608
    ds_read_b64_tr_b16 v[40:41], v8 offset:12288
    s_waitcnt lgkmcnt(8)
    v_mfma_f32_32x32x16_bf16 v[96:111], v[56:59], a[68:71], v[96:111]
    ds_read_b64_tr_b16 v[42:43], v8 offset:12800
    ds_read_b64_tr_b16 v[44:45], v9 offset:12288
    ds_read_b64_tr_b16 v[46:47], v9 offset:12800
    s_waitcnt lgkmcnt(9)
    v_mfma_f32_32x32x16_bf16 v[112:127], v[60:63], a[68:71], v[112:127]
    s_waitcnt lgkmcnt(6)
    v_mfma_f32_32x32x16_bf16 v[64:79], v[32:35], a[72:75], v[64:79]
    ds_read_b128 a[76:79], v5 offset:0
    ds_read_b64_tr_b16 v[48:49], v8 offset:6144
    ds_read_b64_tr_b16 v[50:51], v8 offset:6656
    s_waitcnt lgkmcnt(7)
    v_mfma_f32_32x32x16_bf16 v[80:95], v[36:39], a[72:75], v[80:95]
    ds_read_b64_tr_b16 v[52:53], v9 offset:6144
    ds_read_b64_tr_b16 v[54:55], v9 offset:6656
    ds_read_b64_tr_b16 v[56:57], v8 offset:14336
    s_waitcnt lgkmcnt(8)
    v_mfma_f32_32x32x16_bf16 v[96:111], v[40:43], a[72:75], v[96:111]
    ds_read_b64_tr_b16 v[58:59], v8 offset:14848
    ds_read_b64_tr_b16 v[60:61], v9 offset:14336
    ds_read_b64_tr_b16 v[62:63], v9 offset:14848
    s_waitcnt lgkmcnt(9)
    v_mfma_f32_32x32x16_bf16 v[112:127], v[44:47], a[72:75], v[112:127]
    s_waitcnt lgkmcnt(6)
    s_barrier
    v_mfma_f32_32x32x16_bf16 v[64:79], v[48:51], a[76:79], v[64:79]
    ds_read_b128 a[80:83], v2 offset:16384
    ds_read_b64_tr_b16 v[32:33], v8 offset:16384
    ds_read_b64_tr_b16 v[34:35], v8 offset:16896
    s_waitcnt lgkmcnt(7)
    v_mfma_f32_32x32x16_bf16 v[80:95], v[52:55], a[76:79], v[80:95]
    ds_read_b64_tr_b16 v[36:37], v9 offset:16384
    ds_read_b64_tr_b16 v[38:39], v9 offset:16896
    ds_read_b64_tr_b16 v[40:41], v8 offset:24576
    s_waitcnt lgkmcnt(8)
    v_mfma_f32_32x32x16_bf16 v[96:111], v[56:59], a[76:79], v[96:111]
    ds_read_b64_tr_b16 v[42:43], v8 offset:25088
    ds_read_b64_tr_b16 v[44:45], v9 offset:24576
    ds_read_b64_tr_b16 v[46:47], v9 offset:25088
    s_waitcnt lgkmcnt(9)
    v_mfma_f32_32x32x16_bf16 v[112:127], v[60:63], a[76:79], v[112:127]
    s_waitcnt lgkmcnt(6)
    v_mfma_f32_32x32x16_bf16 v[64:79], v[32:35], a[80:83], v[64:79]
    ds_read_b128 a[84:87], v3 offset:16384
    ds_read_b64_tr_b16 v[48:49], v8 offset:18432
    ds_read_b64_tr_b16 v[50:51], v8 offset:18944
    s_waitcnt lgkmcnt(7)
    v_mfma_f32_32x32x16_bf16 v[80:95], v[36:39], a[80:83], v[80:95]
    ds_read_b64_tr_b16 v[52:53], v9 offset:18432
    ds_read_b64_tr_b16 v[54:55], v9 offset:18944
    ds_read_b64_tr_b16 v[56:57], v8 offset:26624
    s_waitcnt lgkmcnt(8)
    v_mfma_f32_32x32x16_bf16 v[96:111], v[40:43], a[80:83], v[96:111]
    ds_read_b64_tr_b16 v[58:59], v8 offset:27136
    ds_read_b64_tr_b16 v[60:61], v9 offset:26624
    ds_read_b64_tr_b16 v[62:63], v9 offset:27136
    s_waitcnt lgkmcnt(9)
    v_mfma_f32_32x32x16_bf16 v[112:127], v[44:47], a[80:83], v[112:127]
    s_waitcnt lgkmcnt(6)
    v_mfma_f32_32x32x16_bf16 v[64:79], v[48:51], a[84:87], v[64:79]
    ds_read_b128 a[88:91], v4 offset:16384
    ds_read_b64_tr_b16 v[32:33], v8 offset:20480
    ds_read_b64_tr_b16 v[34:35], v8 offset:20992
    s_waitcnt lgkmcnt(7)
    v_mfma_f32_32x32x16_bf16 v[80:95], v[52:55], a[84:87], v[80:95]
    ds_read_b64_tr_b16 v[36:37], v9 offset:20480
    ds_read_b64_tr_b16 v[38:39], v9 offset:20992
    ds_read_b64_tr_b16 v[40:41], v8 offset:28672
    s_waitcnt lgkmcnt(8)
    v_mfma_f32_32x32x16_bf16 v[96:111], v[56:59], a[84:87], v[96:111]
    ds_read_b64_tr_b16 v[42:43], v8 offset:29184
    ds_read_b64_tr_b16 v[44:45], v9 offset:28672
    ds_read_b64_tr_b16 v[46:47], v9 offset:29184
    s_waitcnt lgkmcnt(9)
    v_mfma_f32_32x32x16_bf16 v[112:127], v[60:63], a[84:87], v[112:127]
    s_waitcnt lgkmcnt(6)
    v_mfma_f32_32x32x16_bf16 v[64:79], v[32:35], a[88:91], v[64:79]
    ds_read_b128 a[92:95], v5 offset:16384
    ds_read_b64_tr_b16 v[48:49], v8 offset:22528
    ds_read_b64_tr_b16 v[50:51], v8 offset:23040
    s_waitcnt lgkmcnt(7)
    v_mfma_f32_32x32x16_bf16 v[80:95], v[36:39], a[88:91], v[80:95]
    ds_read_b64_tr_b16 v[52:53], v9 offset:22528
    ds_read_b64_tr_b16 v[54:55], v9 offset:23040
    ds_read_b64_tr_b16 v[56:57], v8 offset:30720
    s_waitcnt lgkmcnt(8)
    v_mfma_f32_32x32x16_bf16 v[96:111], v[40:43], a[88:91], v[96:111]
    ds_read_b64_tr_b16 v[58:59], v8 offset:31232
    ds_read_b64_tr_b16 v[60:61], v9 offset:30720
    ds_read_b64_tr_b16 v[62:63], v9 offset:31232
    s_waitcnt lgkmcnt(9)
    v_mfma_f32_32x32x16_bf16 v[112:127], v[44:47], a[88:91], v[112:127]
    s_waitcnt lgkmcnt(6)
    s_barrier
    v_mfma_f32_32x32x16_bf16 v[64:79], v[48:51], a[92:95], v[64:79]
    ds_read_b128 a[96:99], v2 offset:32768
    ds_read_b64_tr_b16 v[32:33], v8 offset:32768
    ds_read_b64_tr_b16 v[34:35], v8 offset:33280
    s_waitcnt lgkmcnt(7)
    v_mfma_f32_32x32x16_bf16 v[80:95], v[52:55], a[92:95], v[80:95]
    ds_read_b64_tr_b16 v[36:37], v9 offset:32768
    ds_read_b64_tr_b16 v[38:39], v9 offset:33280
    ds_read_b64_tr_b16 v[40:41], v8 offset:40960
    s_waitcnt lgkmcnt(8)
    v_mfma_f32_32x32x16_bf16 v[96:111], v[56:59], a[92:95], v[96:111]
    ds_read_b64_tr_b16 v[42:43], v8 offset:41472
    ds_read_b64_tr_b16 v[44:45], v9 offset:40960
    ds_read_b64_tr_b16 v[46:47], v9 offset:41472
    s_waitcnt lgkmcnt(9)
    v_mfma_f32_32x32x16_bf16 v[112:127], v[60:63], a[92:95], v[112:127]
    s_waitcnt lgkmcnt(6)
    v_mfma_f32_32x32x16_bf16 v[64:79], v[32:35], a[96:99], v[64:79]
    ds_read_b128 a[100:103], v3 offset:32768
    ds_read_b64_tr_b16 v[48:49], v8 offset:34816
    ds_read_b64_tr_b16 v[50:51], v8 offset:35328
    s_waitcnt lgkmcnt(7)
    v_mfma_f32_32x32x16_bf16 v[80:95], v[36:39], a[96:99], v[80:95]
    ds_read_b64_tr_b16 v[52:53], v9 offset:34816
    ds_read_b64_tr_b16 v[54:55], v9 offset:35328
    ds_read_b64_tr_b16 v[56:57], v8 offset:43008
    s_waitcnt lgkmcnt(8)
    v_mfma_f32_32x32x16_bf16 v[96:111], v[40:43], a[96:99], v[96:111]
    ds_read_b64_tr_b16 v[58:59], v8 offset:43520
    ds_read_b64_tr_b16 v[60:61], v9 offset:43008
    ds_read_b64_tr_b16 v[62:63], v9 offset:43520
    s_waitcnt lgkmcnt(9)
    v_mfma_f32_32x32x16_bf16 v[112:127], v[44:47], a[96:99], v[112:127]
    s_waitcnt lgkmcnt(6)
    v_mfma_f32_32x32x16_bf16 v[64:79], v[48:51], a[100:103], v[64:79]
    ds_read_b128 a[104:107], v4 offset:32768
    ds_read_b64_tr_b16 v[32:33], v8 offset:36864
    ds_read_b64_tr_b16 v[34:35], v8 offset:37376
    s_waitcnt lgkmcnt(7)
    v_mfma_f32_32x32x16_bf16 v[80:95], v[52:55], a[100:103], v[80:95]
    ds_read_b64_tr_b16 v[36:37], v9 offset:36864
    ds_read_b64_tr_b16 v[38:39], v9 offset:37376
    ds_read_b64_tr_b16 v[40:41], v8 offset:45056
    s_waitcnt lgkmcnt(8)
    v_mfma_f32_32x32x16_bf16 v[96:111], v[56:59], a[100:103], v[96:111]
    ds_read_b64_tr_b16 v[42:43], v8 offset:45568
    ds_read_b64_tr_b16 v[44:45], v9 offset:45056
    ds_read_b64_tr_b16 v[46:47], v9 offset:45568
    s_waitcnt lgkmcnt(9)
    v_mfma_f32_32x32x16_bf16 v[112:127], v[60:63], a[100:103], v[112:127]
    s_waitcnt lgkmcnt(6)
    v_mfma_f32_32x32x16_bf16 v[64:79], v[32:35], a[104:107], v[64:79]
    ds_read_b128 a[108:111], v5 offset:32768
    ds_read_b64_tr_b16 v[48:49], v8 offset:38912
    ds_read_b64_tr_b16 v[50:51], v8 offset:39424
    s_waitcnt lgkmcnt(7)
    v_mfma_f32_32x32x16_bf16 v[80:95], v[36:39], a[104:107], v[80:95]
    ds_read_b64_tr_b16 v[52:53], v9 offset:38912
    ds_read_b64_tr_b16 v[54:55], v9 offset:39424
    ds_read_b64_tr_b16 v[56:57], v8 offset:47104
    s_waitcnt lgkmcnt(8)
    v_mfma_f32_32x32x16_bf16 v[96:111], v[40:43], a[104:107], v[96:111]
    ds_read_b64_tr_b16 v[58:59], v8 offset:47616
    ds_read_b64_tr_b16 v[60:61], v9 offset:47104
    ds_read_b64_tr_b16 v[62:63], v9 offset:47616
    s_waitcnt lgkmcnt(9)
    v_mfma_f32_32x32x16_bf16 v[112:127], v[44:47], a[104:107], v[112:127]
    s_waitcnt lgkmcnt(6)
    s_barrier
    s_waitcnt vmcnt(0)
    v_mfma_f32_32x32x16_bf16 v[64:79], v[48:51], a[108:111], v[64:79]
    ds_read_b128 a[112:115], v2 offset:49152
    ds_read_b64_tr_b16 v[32:33], v8 offset:49152
    ds_read_b64_tr_b16 v[34:35], v8 offset:49664
    s_waitcnt lgkmcnt(7)
    v_mfma_f32_32x32x16_bf16 v[80:95], v[52:55], a[108:111], v[80:95]
    ds_read_b64_tr_b16 v[36:37], v9 offset:49152
    ds_read_b64_tr_b16 v[38:39], v9 offset:49664
    ds_read_b64_tr_b16 v[40:41], v8 offset:57344
    s_waitcnt lgkmcnt(8)
    v_mfma_f32_32x32x16_bf16 v[96:111], v[56:59], a[108:111], v[96:111]
    ds_read_b64_tr_b16 v[42:43], v8 offset:57856
    ds_read_b64_tr_b16 v[44:45], v9 offset:57344
    ds_read_b64_tr_b16 v[46:47], v9 offset:57856
    s_waitcnt lgkmcnt(9)
    v_mfma_f32_32x32x16_bf16 v[112:127], v[60:63], a[108:111], v[112:127]
    s_waitcnt lgkmcnt(6)
    v_mfma_f32_32x32x16_bf16 v[64:79], v[32:35], a[112:115], v[64:79]
    ds_read_b128 a[116:119], v3 offset:49152
    ds_read_b64_tr_b16 v[48:49], v8 offset:51200
    ds_read_b64_tr_b16 v[50:51], v8 offset:51712
    s_waitcnt lgkmcnt(7)
    v_mfma_f32_32x32x16_bf16 v[80:95], v[36:39], a[112:115], v[80:95]
    ds_read_b64_tr_b16 v[52:53], v9 offset:51200
    ds_read_b64_tr_b16 v[54:55], v9 offset:51712
    ds_read_b64_tr_b16 v[56:57], v8 offset:59392
    s_waitcnt lgkmcnt(8)
    v_mfma_f32_32x32x16_bf16 v[96:111], v[40:43], a[112:115], v[96:111]
    ds_read_b64_tr_b16 v[58:59], v8 offset:59904
    ds_read_b64_tr_b16 v[60:61], v9 offset:59392
    ds_read_b64_tr_b16 v[62:63], v9 offset:59904
    s_waitcnt lgkmcnt(9)
    v_mfma_f32_32x32x16_bf16 v[112:127], v[44:47], a[112:115], v[112:127]
    s_waitcnt lgkmcnt(6)
    v_mfma_f32_32x32x16_bf16 v[64:79], v[48:51], a[116:119], v[64:79]
    ds_read_b128 a[120:123], v4 offset:49152
    ds_read_b64_tr_b16 v[32:33], v8 offset:53248
    ds_read_b64_tr_b16 v[34:35], v8 offset:53760
    s_waitcnt lgkmcnt(7)
    v_mfma_f32_32x32x16_bf16 v[80:95], v[52:55], a[116:119], v[80:95]
    ds_read_b64_tr_b16 v[36:37], v9 offset:53248
    ds_read_b64_tr_b16 v[38:39], v9 offset:53760
    ds_read_b64_tr_b16 v[40:41], v8 offset:61440
    s_waitcnt lgkmcnt(8)
    v_mfma_f32_32x32x16_bf16 v[96:111], v[56:59], a[116:119], v[96:111]
    ds_read_b64_tr_b16 v[42:43], v8 offset:61952
    ds_read_b64_tr_b16 v[44:45], v9 offset:61440
    ds_read_b64_tr_b16 v[46:47], v9 offset:61952
    s_waitcnt lgkmcnt(9)
    v_mfma_f32_32x32x16_bf16 v[112:127], v[60:63], a[116:119], v[112:127]
    ds_read_b32 v24, v10 offset:30752
    s_waitcnt lgkmcnt(7)
    v_mfma_f32_32x32x16_bf16 v[64:79], v[32:35], a[120:123], v[64:79]
    ds_read_b128 a[124:127], v5 offset:49152
    ds_read_b64_tr_b16 v[48:49], v8 offset:55296
    ds_read_b64_tr_b16 v[50:51], v8 offset:55808
    s_waitcnt lgkmcnt(8)
    v_mfma_f32_32x32x16_bf16 v[80:95], v[36:39], a[120:123], v[80:95]
    ds_read_b64_tr_b16 v[52:53], v9 offset:55296
    ds_read_b64_tr_b16 v[54:55], v9 offset:55808
    ds_read_b64_tr_b16 v[56:57], v8 offset:63488
    s_waitcnt lgkmcnt(9)
    v_mfma_f32_32x32x16_bf16 v[96:111], v[40:43], a[120:123], v[96:111]
    ds_read_b64_tr_b16 v[58:59], v8 offset:64000
    ds_read_b64_tr_b16 v[60:61], v9 offset:63488
    ds_read_b64_tr_b16 v[62:63], v9 offset:64000
    s_waitcnt lgkmcnt(10)
    v_mfma_f32_32x32x16_bf16 v[112:127], v[44:47], a[120:123], v[112:127]
    v_mov_b32 v14, 8
    s_mov_b64 exec, 1
    ds_write_b32 v11, v14 offset:30736
    s_mov_b64 exec, -1
    s_waitcnt lgkmcnt(3)
    v_readfirstlane_b32 s65, v24
    s_cmp_ge_u32 s65, 2
    s_cbranch_scc0 L_spc_42
L_spd_43:
    v_mfma_f32_32x32x16_bf16 v[96:111], v[56:59], a[124:127], v[96:111]
    ds_read_b64 v[28:29], v28 offset:18432
    ds_read_b64 v[12:13], v22 offset:22528
    ds_read_b64 v[14:15], v22 offset:23040
    s_waitcnt lgkmcnt(4)
    v_mfma_f32_32x32x16_bf16 v[112:127], v[60:63], a[124:127], v[112:127]
    ds_read_b64 v[24:25], v22 offset:21504
    ds_read_b64 v[26:27], v22 offset:22016
    ds_read_b32 v16, v16 offset:20480
    v_mfma_f32_32x32x16_bf16 v[64:79], v[48:51], a[124:127], v[64:79]
    ds_read_b32 v17, v10 offset:30772
    v_mfma_f32_32x32x16_bf16 v[80:95], v[52:55], a[124:127], v[80:95]
    s_waitcnt lgkmcnt(0)
    v_mfma_f32_32x32x8_bf16 v[96:111], v[12:13], v[28:29], v[96:111]
    v_mfma_f32_32x32x8_bf16 v[112:127], v[14:15], v[28:29], v[112:127]
    v_mfma_f32_32x32x8_bf16 v[64:79], v[24:25], v[28:29], v[64:79]
    v_mfma_f32_32x32x8_bf16 v[80:95], v[26:27], v[28:29], v[80:95]
    v_readfirstlane_b32 s36, v17
    v_mov_b32 v17, v16
    v_mul_f32 v18, 0x3fb8aa3b, v16
    v_mul_f32 v19, 0x3fb8aa3b, v16
    s_cmp_lg_u32 s28, 0
    s_cbranch_scc1 L_C_ffn1
    ds_read_b128 v[32:35], v23 offset:26624
    ds_read_b128 v[36:39], v23 offset:27648
    ds_read_b128 v[40:43], v23 offset:28672
    ds_read_b128 v[44:47], v23 offset:29696
    v_mov_b32 v48, 0x3f803f80
    v_mov_b32 v49, v48
    v_mov_b32 v50, v48
    v_mov_b32 v51, v48
    v_lshrrev_b32 v2, 5, v0
    v_lshlrev_b32 v2, 4, v2
    v_sub_u32 v2, v30, v2
    ds_write_b128 v2, v[48:51] offset:128
    v_pk_mul_f32 v[96:97], v[96:97], v[16:17]
    v_pk_mul_f32 v[98:99], v[98:99], v[16:17]
    v_pk_mul_f32 v[100:101], v[100:101], v[16:17]
    v_pk_mul_f32 v[102:103], v[102:103], v[16:17]
    v_pk_mul_f32 v[104:105], v[104:105], v[16:17]
    v_pk_mul_f32 v[106:107], v[106:107], v[16:17]
    v_pk_mul_f32 v[108:109], v[108:109], v[16:17]
    v_pk_mul_f32 v[110:111], v[110:111], v[16:17]
    v_cvt_pk_bf16_f32 v48, v96, v97
    v_cvt_pk_bf16_f32 v49, v98, v99
    v_cvt_pk_bf16_f32 v50, v100, v101
    v_cvt_pk_bf16_f32 v51, v102, v103
    v_cvt_pk_bf16_f32 v52, v104, v105
    v_cvt_pk_bf16_f32 v53, v106, v107
    v_cvt_pk_bf16_f32 v54, v108, v109
    v_cvt_pk_bf16_f32 v55, v110, v111
    ds_write_b128 v30, v[48:51] offset:0
    ds_write_b128 v30, v[52:55] offset:32
    v_pk_mul_f32 v[112:113], v[112:113], v[16:17]
    v_pk_mul_f32 v[114:115], v[114:115], v[16:17]
    v_pk_mul_f32 v[116:117], v[116:117], v[16:17]
    v_pk_mul_f32 v[118:119], v[118:119], v[16:17]
    v_pk_mul_f32 v[120:121], v[120:121], v[16:17]
    v_pk_mul_f32 v[122:123], v[122:123], v[16:17]
    v_pk_mul_f32 v[124:125], v[124:125], v[16:17]
    v_pk_mul_f32 v[126:127], v[126:127], v[16:17]
    v_cvt_pk_bf16_f32 v56, v112, v113
    v_cvt_pk_bf16_f32 v57, v114, v115
    v_cvt_pk_bf16_f32 v58, v116, v117
    v_cvt_pk_bf16_f32 v59, v118, v119
    v_cvt_pk_bf16_f32 v60, v120, v121
    v_cvt_pk_bf16_f32 v61, v122, v123
    v_cvt_pk_bf16_f32 v62, v124, v125
    v_cvt_pk_bf16_f32 v63, v126, v127
    ds_write_b128 v30, v[56:59] offset:64
    ds_write_b128 v30, v[60:63] offset:96
    v_cvt_pk_bf16_f32 v64, v64, v65
    v_cvt_pk_bf16_f32 v65, v66, v67
    v_cvt_pk_bf16_f32 v66, v68, v69
    v_cvt_pk_bf16_f32 v67, v70, v71
    v_cvt_pk_bf16_f32 v68, v72, v73
    v_cvt_pk_bf16_f32 v69, v74, v75
    v_cvt_pk_bf16_f32 v70, v76, v77
    v_cvt_pk_bf16_f32 v71, v78, v79
    v_cvt_pk_bf16_f32 v80, v80, v81
    v_cvt_pk_bf16_f32 v81, v82, v83
    v_cvt_pk_bf16_f32 v82, v84, v85
    v_cvt_pk_bf16_f32 v83, v86, v87
    v_cvt_pk_bf16_f32 v84, v88, v89
    v_cvt_pk_bf16_f32 v85, v90, v91
    v_cvt_pk_bf16_f32 v86, v92, v93
    v_cvt_pk_bf16_f32 v87, v94, v95
    s_waitcnt lgkmcnt(5)
    v_mfma_f32_32x32x16_bf16 v[96:111], v[32:35], v[64:67], 0
    v_mfma_f32_32x32x16_bf16 v[112:127], v[36:39], v[68:71], 0
    v_xor_b32 v3, 16, v31
    v_add_u32 v4, 65536, v31
    v_xor_b32 v2, 16, v4
    s_waitcnt lgkmcnt(0)
    v_mfma_f32_32x32x16_bf16 v[48:63], v[40:43], v[80:83], 0
    s_nop 6
    v_max3_f32 v24, v96, v97, v98
    v_max3_f32 v12, v112, v113, v114
    v_max3_f32 v25, v99, v100, v101
    v_max3_f32 v13, v115, v116, v117
    v_max3_f32 v26, v102, v103, v104
    v_max3_f32 v14, v118, v119, v120
    v_max3_f32 v27, v105, v106, v107
    v_max3_f32 v15, v121, v122, v123
    v_max3_f32 v24, v24, v108, v109
    v_max3_f32 v12, v12, v124, v125
    v_max3_f32 v25, v25, v110, v111
    v_max3_f32 v13, v13, v126, v127
    v_max3_f32 v24, v24, v26, v27
    v_max3_f32 v12, v12, v14, v15
    v_max_f32 v24, v24, v25
    v_max_f32 v12, v12, v13
    v_mul_f32 v24, v24, v18
    v_mul_f32 v12, v12, v18
    v_pk_fma_f32 v[96:97], v[96:97], v[18:19], v[24:25] op_sel_hi:[1,1,0] neg_lo:[0,0,1] neg_hi:[0,0,1]
    v_pk_fma_f32 v[112:113], v[112:113], v[18:19], v[12:13] op_sel_hi:[1,1,0] neg_lo:[0,0,1] neg_hi:[0,0,1]
    v_pk_fma_f32 v[98:99], v[98:99], v[18:19], v[24:25] op_sel_hi:[1,1,0] neg_lo:[0,0,1] neg_hi:[0,0,1]
    v_pk_fma_f32 v[114:115], v[114:115], v[18:19], v[12:13] op_sel_hi:[1,1,0] neg_lo:[0,0,1] neg_hi:[0,0,1]
    v_pk_fma_f32 v[100:101], v[100:101], v[18:19], v[24:25] op_sel_hi:[1,1,0] neg_lo:[0,0,1] neg_hi:[0,0,1]
    v_pk_fma_f32 v[116:117], v[116:117], v[18:19], v[12:13] op_sel_hi:[1,1,0] neg_lo:[0,0,1] neg_hi:[0,0,1]
    v_pk_fma_f32 v[102:103], v[102:103], v[18:19], v[24:25] op_sel_hi:[1,1,0] neg_lo:[0,0,1] neg_hi:[0,0,1]
    v_pk_fma_f32 v[118:119], v[118:119], v[18:19], v[12:13] op_sel_hi:[1,1,0] neg_lo:[0,0,1] neg_hi:[0,0,1]
    v_pk_fma_f32 v[104:105], v[104:105], v[18:19], v[24:25] op_sel_hi:[1,1,0] neg_lo:[0,0,1] neg_hi:[0,0,1]
    v_pk_fma_f32 v[120:121], v[120:121], v[18:19], v[12:13] op_sel_hi:[1,1,0] neg_lo:[0,0,1] neg_hi:[0,0,1]
    v_pk_fma_f32 v[106:107], v[106:107], v[18:19], v[24:25] op_sel_hi:[1,1,0] neg_lo:[0,0,1] neg_hi:[0,0,1]
    v_pk_fma_f32 v[122:123], v[122:123], v[18:19], v[12:13] op_sel_hi:[1,1,0] neg_lo:[0,0,1] neg_hi:[0,0,1]
    v_pk_fma_f32 v[108:109], v[108:109], v[18:19], v[24:25] op_sel_hi:[1,1,0] neg_lo:[0,0,1] neg_hi:[0,0,1]
    v_pk_fma_f32 v[124:125], v[124:125], v[18:19], v[12:13] op_sel_hi:[1,1,0] neg_lo:[0,0,1] neg_hi:[0,0,1]
    v_pk_fma_f32 v[110:111], v[110:111], v[18:19], v[24:25] op_sel_hi:[1,1,0] neg_lo:[0,0,1] neg_hi:[0,0,1]
    v_pk_fma_f32 v[126:127], v[126:127], v[18:19], v[12:13] op_sel_hi:[1,1,0] neg_lo:[0,0,1] neg_hi:[0,0,1]
    v_exp_f32 v96, v96
    v_exp_f32 v112, v112
    v_exp_f32 v97, v97
    v_exp_f32 v113, v113
    v_exp_f32 v98, v98
    v_exp_f32 v114, v114
    v_exp_f32 v99, v99
    v_exp_f32 v115, v115
    v_exp_f32 v100, v100
    v_exp_f32 v116, v116
    v_exp_f32 v101, v101
    v_exp_f32 v117, v117
    v_exp_f32 v102, v102
    v_exp_f32 v118, v118
    v_exp_f32 v103, v103
    v_exp_f32 v119, v119
    v_exp_f32 v104, v104
    v_exp_f32 v120, v120
    v_exp_f32 v105, v105
    v_exp_f32 v121, v121
    v_exp_f32 v106, v106
    v_exp_f32 v122, v122
    v_exp_f32 v107, v107
    v_exp_f32 v123, v123
    v_exp_f32 v108, v108
    v_exp_f32 v124, v124
    v_exp_f32 v109, v109
    v_exp_f32 v125, v125
    v_exp_f32 v110, v110
    v_exp_f32 v126, v126
    v_exp_f32 v111, v111
    v_exp_f32 v127, v127
    v_pk_add_f32 v[24:25], v[96:97], v[98:99]
    v_pk_add_f32 v[12:13], v[112:113], v[114:115]
    v_pk_add_f32 v[26:27], v[100:101], v[102:103]
    v_pk_add_f32 v[14:15], v[116:117], v[118:119]
    v_pk_add_f32 v[24:25], v[24:25], v[104:105]
    v_pk_add_f32 v[12:13], v[12:13], v[120:121]
    v_pk_add_f32 v[26:27], v[26:27], v[106:107]
    v_pk_add_f32 v[14:15], v[14:15], v[122:123]
    v_pk_add_f32 v[24:25], v[24:25], v[108:109]
    v_pk_add_f32 v[12:13], v[12:13], v[124:125]
    v_pk_add_f32 v[26:27], v[26:27], v[110:111]
    v_pk_add_f32 v[14:15], v[14:15], v[126:127]
    v_pk_add_f32 v[24:25], v[24:25], v[26:27]
    v_pk_add_f32 v[12:13], v[12:13], v[14:15]
    v_add_f32 v24, v24, v25
    v_add_f32 v12, v12, v13
    v_rcp_f32 v24, v24
    v_rcp_f32 v12, v12
    s_nop 0
    v_pk_mul_f32 v[96:97], v[96:97], v[24:25] op_sel_hi:[1,0]
    v_pk_mul_f32 v[112:113], v[112:113], v[12:13] op_sel_hi:[1,0]
    v_pk_mul_f32 v[98:99], v[98:99], v[24:25] op_sel_hi:[1,0]
    v_pk_mul_f32 v[114:115], v[114:115], v[12:13] op_sel_hi:[1,0]
    v_pk_mul_f32 v[100:101], v[100:101], v[24:25] op_sel_hi:[1,0]
    v_pk_mul_f32 v[116:117], v[116:117], v[12:13] op_sel_hi:[1,0]
    v_pk_mul_f32 v[102:103], v[102:103], v[24:25] op_sel_hi:[1,0]
    v_pk_mul_f32 v[118:119], v[118:119], v[12:13] op_sel_hi:[1,0]
    v_pk_mul_f32 v[104:105], v[104:105], v[24:25] op_sel_hi:[1,0]
    v_pk_mul_f32 v[120:121], v[120:121], v[12:13] op_sel_hi:[1,0]
    v_pk_mul_f32 v[106:107], v[106:107], v[24:25] op_sel_hi:[1,0]
    v_pk_mul_f32 v[122:123], v[122:123], v[12:13] op_sel_hi:[1,0]
    v_pk_mul_f32 v[108:109], v[108:109], v[24:25] op_sel_hi:[1,0]
    v_pk_mul_f32 v[124:125], v[124:125], v[12:13] op_sel_hi:[1,0]
    v_pk_mul_f32 v[110:111], v[110:111], v[24:25] op_sel_hi:[1,0]
    v_pk_mul_f32 v[126:127], v[126:127], v[12:13] op_sel_hi:[1,0]
    v_cvt_pk_bf16_f32 v64, v96, v97
    v_cvt_pk_bf16_f32 v72, v112, v113
    v_cvt_pk_bf16_f32 v65, v98, v99
    v_cvt_pk_bf16_f32 v73, v114, v115
    v_cvt_pk_bf16_f32 v66, v100, v101
    v_cvt_pk_bf16_f32 v74, v116, v117
    v_cvt_pk_bf16_f32 v67, v102, v103
    v_cvt_pk_bf16_f32 v75, v118, v119
    v_cvt_pk_bf16_f32 v68, v104, v105
    v_cvt_pk_bf16_f32 v76, v120, v121
    v_cvt_pk_bf16_f32 v69, v106, v107
    v_cvt_pk_bf16_f32 v77, v122, v123
    v_cvt_pk_bf16_f32 v70, v108, v109
    v_cvt_pk_bf16_f32 v78, v124, v125
    v_cvt_pk_bf16_f32 v71, v110, v111
    v_cvt_pk_bf16_f32 v79, v126, v127
    v_mfma_f32_32x32x16_bf16 v[96:111], v[44:47], v[84:87], 0
    ds_write_b128 v31, v[64:67] offset:0
    ds_write_b128 v3, v[68:71] offset:0
    ds_write_b128 v31, v[72:75] offset:8192
    ds_write_b128 v3, v[76:79] offset:8192
    s_nop 7
    v_max3_f32 v24, v48, v49, v50
    v_max3_f32 v12, v96, v97, v98
    v_max3_f32 v25, v51, v52, v53
    v_max3_f32 v13, v99, v100, v101
    v_max3_f32 v26, v54, v55, v56
    v_max3_f32 v14, v102, v103, v104
    v_max3_f32 v27, v57, v58, v59
    v_max3_f32 v15, v105, v106, v107
    v_max3_f32 v24, v24, v60, v61
    v_max3_f32 v12, v12, v108, v109
    v_max3_f32 v25, v25, v62, v63
    v_max3_f32 v13, v13, v110, v111
    v_max3_f32 v24, v24, v26, v27
    v_max3_f32 v12, v12, v14, v15
    v_max_f32 v24, v24, v25
    v_max_f32 v12, v12, v13
    v_mul_f32 v24, v24, v18
    v_mul_f32 v12, v12, v18
    v_pk_fma_f32 v[48:49], v[48:49], v[18:19], v[24:25] op_sel_hi:[1,1,0] neg_lo:[0,0,1] neg_hi:[0,0,1]
    v_pk_fma_f32 v[96:97], v[96:97], v[18:19], v[12:13] op_sel_hi:[1,1,0] neg_lo:[0,0,1] neg_hi:[0,0,1]
    v_pk_fma_f32 v[50:51], v[50:51], v[18:19], v[24:25] op_sel_hi:[1,1,0] neg_lo:[0,0,1] neg_hi:[0,0,1]
    v_pk_fma_f32 v[98:99], v[98:99], v[18:19], v[12:13] op_sel_hi:[1,1,0] neg_lo:[0,0,1] neg_hi:[0,0,1]
    v_pk_fma_f32 v[52:53], v[52:53], v[18:19], v[24:25] op_sel_hi:[1,1,0] neg_lo:[0,0,1] neg_hi:[0,0,1]
    v_pk_fma_f32 v[100:101], v[100:101], v[18:19], v[12:13] op_sel_hi:[1,1,0] neg_lo:[0,0,1] neg_hi:[0,0,1]
    v_pk_fma_f32 v[54:55], v[54:55], v[18:19], v[24:25] op_sel_hi:[1,1,0] neg_lo:[0,0,1] neg_hi:[0,0,1]
    v_pk_fma_f32 v[102:103], v[102:103], v[18:19], v[12:13] op_sel_hi:[1,1,0] neg_lo:[0,0,1] neg_hi:[0,0,1]
    v_pk_fma_f32 v[56:57], v[56:57], v[18:19], v[24:25] op_sel_hi:[1,1,0] neg_lo:[0,0,1] neg_hi:[0,0,1]
    v_pk_fma_f32 v[104:105], v[104:105], v[18:19], v[12:13] op_sel_hi:[1,1,0] neg_lo:[0,0,1] neg_hi:[0,0,1]
    v_pk_fma_f32 v[58:59], v[58:59], v[18:19], v[24:25] op_sel_hi:[1,1,0] neg_lo:[0,0,1] neg_hi:[0,0,1]
    v_pk_fma_f32 v[106:107], v[106:107], v[18:19], v[12:13] op_sel_hi:[1,1,0] neg_lo:[0,0,1] neg_hi:[0,0,1]
    v_pk_fma_f32 v[60:61], v[60:61], v[18:19], v[24:25] op_sel_hi:[1,1,0] neg_lo:[0,0,1] neg_hi:[0,0,1]
    v_pk_fma_f32 v[108:109], v[108:109], v[18:19], v[12:13] op_sel_hi:[1,1,0] neg_lo:[0,0,1] neg_hi:[0,0,1]
    v_pk_fma_f32 v[62:63], v[62:63], v[18:19], v[24:25] op_sel_hi:[1,1,0] neg_lo:[0,0,1] neg_hi:[0,0,1]
    v_pk_fma_f32 v[110:111], v[110:111], v[18:19], v[12:13] op_sel_hi:[1,1,0] neg_lo:[0,0,1] neg_hi:[0,0,1]
    v_exp_f32 v48, v48
    v_exp_f32 v96, v96
    v_exp_f32 v49, v49
    v_exp_f32 v97, v97
    v_exp_f32 v50, v50
    v_exp_f32 v98, v98
    v_exp_f32 v51, v51
    v_exp_f32 v99, v99
    v_exp_f32 v52, v52
    v_exp_f32 v100, v100
    v_exp_f32 v53, v53
    v_exp_f32 v101, v101
    v_exp_f32 v54, v54
    v_exp_f32 v102, v102
    v_exp_f32 v55, v55
    v_exp_f32 v103, v103
    v_exp_f32 v56, v56
    v_exp_f32 v104, v104
    v_exp_f32 v57, v57
    v_exp_f32 v105, v105
    v_exp_f32 v58, v58
    v_exp_f32 v106, v106
    v_exp_f32 v59, v59
    v_exp_f32 v107, v107
    v_exp_f32 v60, v60
    v_exp_f32 v108, v108
    v_exp_f32 v61, v61
    v_exp_f32 v109, v109
    v_exp_f32 v62, v62
    v_exp_f32 v110, v110
    v_exp_f32 v63, v63
    v_exp_f32 v111, v111
    v_pk_add_f32 v[24:25], v[48:49], v[50:51]
    v_pk_add_f32 v[12:13], v[96:97], v[98:99]
    v_pk_add_f32 v[26:27], v[52:53], v[54:55]
    v_pk_add_f32 v[14:15], v[100:101], v[102:103]
    v_pk_add_f32 v[24:25], v[24:25], v[56:57]
    v_pk_add_f32 v[12:13], v[12:13], v[104:105]
    v_pk_add_f32 v[26:27], v[26:27], v[58:59]
    v_pk_add_f32 v[14:15], v[14:15], v[106:107]
    v_pk_add_f32 v[24:25], v[24:25], v[60:61]
    v_pk_add_f32 v[12:13], v[12:13], v[108:109]
    v_pk_add_f32 v[26:27], v[26:27], v[62:63]
    v_pk_add_f32 v[14:15], v[14:15], v[110:111]
    v_pk_add_f32 v[24:25], v[24:25], v[26:27]
    v_pk_add_f32 v[12:13], v[12:13], v[14:15]
    v_add_f32 v24, v24, v25
    v_add_f32 v12, v12, v13
    v_rcp_f32 v24, v24
    v_rcp_f32 v12, v12
    s_nop 0
    v_pk_mul_f32 v[48:49], v[48:49], v[24:25] op_sel_hi:[1,0]
    v_pk_mul_f32 v[96:97], v[96:97], v[12:13] op_sel_hi:[1,0]
    v_pk_mul_f32 v[50:51], v[50:51], v[24:25] op_sel_hi:[1,0]
    v_pk_mul_f32 v[98:99], v[98:99], v[12:13] op_sel_hi:[1,0]
    v_pk_mul_f32 v[52:53], v[52:53], v[24:25] op_sel_hi:[1,0]
    v_pk_mul_f32 v[100:101], v[100:101], v[12:13] op_sel_hi:[1,0]
    v_pk_mul_f32 v[54:55], v[54:55], v[24:25] op_sel_hi:[1,0]
    v_pk_mul_f32 v[102:103], v[102:103], v[12:13] op_sel_hi:[1,0]
    v_pk_mul_f32 v[56:57], v[56:57], v[24:25] op_sel_hi:[1,0]
    v_pk_mul_f32 v[104:105], v[104:105], v[12:13] op_sel_hi:[1,0]
    v_pk_mul_f32 v[58:59], v[58:59], v[24:25] op_sel_hi:[1,0]
    v_pk_mul_f32 v[106:107], v[106:107], v[12:13] op_sel_hi:[1,0]
    v_pk_mul_f32 v[60:61], v[60:61], v[24:25] op_sel_hi:[1,0]
    v_pk_mul_f32 v[108:109], v[108:109], v[12:13] op_sel_hi:[1,0]
    v_pk_mul_f32 v[62:63], v[62:63], v[24:25] op_sel_hi:[1,0]
    v_pk_mul_f32 v[110:111], v[110:111], v[12:13] op_sel_hi:[1,0]
    v_cvt_pk_bf16_f32 v80, v48, v49
    v_cvt_pk_bf16_f32 v88, v96, v97
    v_cvt_pk_bf16_f32 v81, v50, v51
    v_cvt_pk_bf16_f32 v89, v98, v99
    v_cvt_pk_bf16_f32 v82, v52, v53
    v_cvt_pk_bf16_f32 v90, v100, v101
    v_cvt_pk_bf16_f32 v83, v54, v55
    v_cvt_pk_bf16_f32 v91, v102, v103
    v_cvt_pk_bf16_f32 v84, v56, v57
    v_cvt_pk_bf16_f32 v92, v104, v105
    v_cvt_pk_bf16_f32 v85, v58, v59
    v_cvt_pk_bf16_f32 v93, v106, v107
    v_cvt_pk_bf16_f32 v86, v60, v61
    v_cvt_pk_bf16_f32 v94, v108, v109
    v_cvt_pk_bf16_f32 v87, v62, v63
    v_cvt_pk_bf16_f32 v95, v110, v111
    ds_write_b128 v4, v[80:83] offset:0
    ds_write_b128 v2, v[84:87] offset:0
    ds_write_b128 v4, v[88:91] offset:8192
    ds_write_b128 v2, v[92:95] offset:8192
    v_mov_b32 v14, 1
    s_mov_b64 exec, 1
    ds_add_u32 v10, v14 offset:30756
    s_mov_b64 exec, -1
    s_branch L_C_b9
L_C_ffn1:
    s_lshl_b32 s68, s29, 13
    s_add_u32 s69, s70, s68
    s_nop 2
    s_add_u32 s68, s69, 4096
    v_max_f32 v96, 0, v96
    v_max_f32 v97, 0, v97
    v_max_f32 v98, 0, v98
    v_max_f32 v99, 0, v99
    v_max_f32 v100, 0, v100
    v_max_f32 v101, 0, v101
    v_max_f32 v102, 0, v102
    v_max_f32 v103, 0, v103
    v_max_f32 v104, 0, v104
    v_max_f32 v105, 0, v105
    v_max_f32 v106, 0, v106
    v_max_f32 v107, 0, v107
    v_max_f32 v108, 0, v108
    v_max_f32 v109, 0, v109
    v_max_f32 v110, 0, v110
    v_max_f32 v111, 0, v111
    v_pk_mul_f32 v[96:97], v[96:97], v[16:17]
    v_pk_mul_f32 v[98:99], v[98:99], v[16:17]
    v_pk_mul_f32 v[100:101], v[100:101], v[16:17]
    v_pk_mul_f32 v[102:103], v[102:103], v[16:17]
    v_pk_mul_f32 v[104:105], v[104:105], v[16:17]
    v_pk_mul_f32 v[106:107], v[106:107], v[16:17]
    v_pk_mul_f32 v[108:109], v[108:109], v[16:17]
    v_pk_mul_f32 v[110:111], v[110:111], v[16:17]
    v_pk_mul_f32 v[96:97], v[96:97], v[96:97]
    v_pk_mul_f32 v[98:99], v[98:99], v[98:99]
    v_pk_mul_f32 v[100:101], v[100:101], v[100:101]
    v_pk_mul_f32 v[102:103], v[102:103], v[102:103]
    v_pk_mul_f32 v[104:105], v[104:105], v[104:105]
    v_pk_mul_f32 v[106:107], v[106:107], v[106:107]
    v_pk_mul_f32 v[108:109], v[108:109], v[108:109]
    v_pk_mul_f32 v[110:111], v[110:111], v[110:111]
    v_cvt_pk_bf16_f32 v96, v96, v97
    v_cvt_pk_bf16_f32 v97, v98, v99
    v_cvt_pk_bf16_f32 v98, v100, v101
    v_cvt_pk_bf16_f32 v99, v102, v103
    v_cvt_pk_bf16_f32 v100, v104, v105
    v_cvt_pk_bf16_f32 v101, v106, v107
    v_cvt_pk_bf16_f32 v102, v108, v109
    v_cvt_pk_bf16_f32 v103, v110, v111
    s_cmp_eq_u32 s36, 0
    s_cbranch_scc1 L_wt_44
    buffer_store_dwordx4 v[96:99], v1, s[52:55], s68 offen
    buffer_store_dwordx4 v[100:103], v1, s[52:55], s68 offen offset:1024
L_wtb_45:
    s_add_u32 s68, s69, 6144
    v_max_f32 v112, 0, v112
    v_max_f32 v113, 0, v113
    v_max_f32 v114, 0, v114
    v_max_f32 v115, 0, v115
    v_max_f32 v116, 0, v116
    v_max_f32 v117, 0, v117
    v_max_f32 v118, 0, v118
    v_max_f32 v119, 0, v119
    v_max_f32 v120, 0, v120
    v_max_f32 v121, 0, v121
    v_max_f32 v122, 0, v122
    v_max_f32 v123, 0, v123
    v_max_f32 v124, 0, v124
    v_max_f32 v125, 0, v125
    v_max_f32 v126, 0, v126
    v_max_f32 v127, 0, v127
    v_pk_mul_f32 v[112:113], v[112:113], v[16:17]
    v_pk_mul_f32 v[114:115], v[114:115], v[16:17]
    v_pk_mul_f32 v[116:117], v[116:117], v[16:17]
    v_pk_mul_f32 v[118:119], v[118:119], v[16:17]
    v_pk_mul_f32 v[120:121], v[120:121], v[16:17]
    v_pk_mul_f32 v[122:123], v[122:123], v[16:17]
    v_pk_mul_f32 v[124:125], v[124:125], v[16:17]
    v_pk_mul_f32 v[126:127], v[126:127], v[16:17]
    v_pk_mul_f32 v[112:113], v[112:113], v[112:113]
    v_pk_mul_f32 v[114:115], v[114:115], v[114:115]
    v_pk_mul_f32 v[116:117], v[116:117], v[116:117]
    v_pk_mul_f32 v[118:119], v[118:119], v[118:119]
    v_pk_mul_f32 v[120:121], v[120:121], v[120:121]
    v_pk_mul_f32 v[122:123], v[122:123], v[122:123]
    v_pk_mul_f32 v[124:125], v[124:125], v[124:125]
    v_pk_mul_f32 v[126:127], v[126:127], v[126:127]
    v_cvt_pk_bf16_f32 v112, v112, v113
    v_cvt_pk_bf16_f32 v113, v114, v115
    v_cvt_pk_bf16_f32 v114, v116, v117
    v_cvt_pk_bf16_f32 v115, v118, v119
    v_cvt_pk_bf16_f32 v116, v120, v121
    v_cvt_pk_bf16_f32 v117, v122, v123
    v_cvt_pk_bf16_f32 v118, v124, v125
    v_cvt_pk_bf16_f32 v119, v126, v127
    s_cmp_eq_u32 s36, 0
    s_cbranch_scc1 L_wt_46
    buffer_store_dwordx4 v[112:115], v1, s[52:55], s68 offen
    buffer_store_dwordx4 v[116:119], v1, s[52:55], s68 offen offset:1024
L_wtb_47:
    s_add_u32 s68, s69, 0
    v_max_f32 v64, 0, v64
    v_max_f32 v65, 0, v65
    v_max_f32 v66, 0, v66
    v_max_f32 v67, 0, v67
    v_max_f32 v68, 0, v68
    v_max_f32 v69, 0, v69
    v_max_f32 v70, 0, v70
    v_max_f32 v71, 0, v71
    v_max_f32 v72, 0, v72
    v_max_f32 v73, 0, v73
    v_max_f32 v74, 0, v74
    v_max_f32 v75, 0, v75
    v_max_f32 v76, 0, v76
    v_max_f32 v77, 0, v77
    v_max_f32 v78, 0, v78
    v_max_f32 v79, 0, v79
    v_pk_mul_f32 v[64:65], v[64:65], v[16:17]
    v_pk_mul_f32 v[66:67], v[66:67], v[16:17]
    v_pk_mul_f32 v[68:69], v[68:69], v[16:17]
    v_pk_mul_f32 v[70:71], v[70:71], v[16:17]
    v_pk_mul_f32 v[72:73], v[72:73], v[16:17]
    v_pk_mul_f32 v[74:75], v[74:75], v[16:17]
    v_pk_mul_f32 v[76:77], v[76:77], v[16:17]
    v_pk_mul_f32 v[78:79], v[78:79], v[16:17]
    v_pk_mul_f32 v[64:65], v[64:65], v[64:65]
    v_pk_mul_f32 v[66:67], v[66:67], v[66:67]
    v_pk_mul_f32 v[68:69], v[68:69], v[68:69]
    v_pk_mul_f32 v[70:71], v[70:71], v[70:71]
    v_pk_mul_f32 v[72:73], v[72:73], v[72:73]
    v_pk_mul_f32 v[74:75], v[74:75], v[74:75]
    v_pk_mul_f32 v[76:77], v[76:77], v[76:77]
    v_pk_mul_f32 v[78:79], v[78:79], v[78:79]
    v_cvt_pk_bf16_f32 v64, v64, v65
    v_cvt_pk_bf16_f32 v65, v66, v67
    v_cvt_pk_bf16_f32 v66, v68, v69
    v_cvt_pk_bf16_f32 v67, v70, v71
    v_cvt_pk_bf16_f32 v68, v72, v73
    v_cvt_pk_bf16_f32 v69, v74, v75
    v_cvt_pk_bf16_f32 v70, v76, v77
    v_cvt_pk_bf16_f32 v71, v78, v79
    s_cmp_eq_u32 s36, 0
    s_cbranch_scc1 L_wt_48
    buffer_store_dwordx4 v[64:67], v1, s[52:55], s68 offen
    buffer_store_dwordx4 v[68:71], v1, s[52:55], s68 offen offset:1024
L_wtb_49:
    s_add_u32 s68, s69, 2048
    v_max_f32 v80, 0, v80
    v_max_f32 v81, 0, v81
    v_max_f32 v82, 0, v82
    v_max_f32 v83, 0, v83
    v_max_f32 v84, 0, v84
    v_max_f32 v85, 0, v85
    v_max_f32 v86, 0, v86
    v_max_f32 v87, 0, v87
    v_max_f32 v88, 0, v88
    v_max_f32 v89, 0, v89
    v_max_f32 v90, 0, v90
    v_max_f32 v91, 0, v91
    v_max_f32 v92, 0, v92
    v_max_f32 v93, 0, v93
    v_max_f32 v94, 0, v94
    v_max_f32 v95, 0, v95
    v_pk_mul_f32 v[80:81], v[80:81], v[16:17]
    v_pk_mul_f32 v[82:83], v[82:83], v[16:17]
    v_pk_mul_f32 v[84:85], v[84:85], v[16:17]
    v_pk_mul_f32 v[86:87], v[86:87], v[16:17]
    v_pk_mul_f32 v[88:89], v[88:89], v[16:17]
    v_pk_mul_f32 v[90:91], v[90:91], v[16:17]
    v_pk_mul_f32 v[92:93], v[92:93], v[16:17]
    v_pk_mul_f32 v[94:95], v[94:95], v[16:17]
    v_pk_mul_f32 v[80:81], v[80:81], v[80:81]
    v_pk_mul_f32 v[82:83], v[82:83], v[82:83]
    v_pk_mul_f32 v[84:85], v[84:85], v[84:85]
    v_pk_mul_f32 v[86:87], v[86:87], v[86:87]
    v_pk_mul_f32 v[88:89], v[88:89], v[88:89]
    v_pk_mul_f32 v[90:91], v[90:91], v[90:91]
    v_pk_mul_f32 v[92:93], v[92:93], v[92:93]
    v_pk_mul_f32 v[94:95], v[94:95], v[94:95]
    v_cvt_pk_bf16_f32 v80, v80, v81
    v_cvt_pk_bf16_f32 v81, v82, v83
    v_cvt_pk_bf16_f32 v82, v84, v85
    v_cvt_pk_bf16_f32 v83, v86, v87
    v_cvt_pk_bf16_f32 v84, v88, v89
    v_cvt_pk_bf16_f32 v85, v90, v91
    v_cvt_pk_bf16_f32 v86, v92, v93
    v_cvt_pk_bf16_f32 v87, v94, v95
    s_cmp_eq_u32 s36, 0
    s_cbranch_scc1 L_wt_50
    buffer_store_dwordx4 v[80:83], v1, s[52:55], s68 offen
    buffer_store_dwordx4 v[84:87], v1, s[52:55], s68 offen offset:1024
L_wtb_51:
L_C_b9:
    v_mov_b32 v14, 9
    s_mov_b64 exec, 1
    ds_write_b32 v11, v14 offset:30736
    s_mov_b64 exec, -1
    s_mov_b32 s64, 0
L_sp_52:
    ds_read_b64 v[12:13], v10 offset:30720
    s_waitcnt lgkmcnt(0)
    v_min_u32 v12, v12, v13
    s_nop 0
    v_readfirstlane_b32 s65, v12
    s_add_u32 s64, s64, 1
    s_cmp_ge_u32 s65, 10
    s_cbranch_scc1 L_spd_54
    s_cmp_lt_u32 s64, 400000
    s_cbranch_scc1 L_sp_52
L_spd_54:
    ds_read_b64_tr_b16 v[32:33], v6 offset:0
    ds_read_b64_tr_b16 v[34:35], v6 offset:512
    ds_read_b64_tr_b16 v[36:37], v7 offset:0
    ds_read_b64_tr_b16 v[38:39], v7 offset:512
    ds_read_b64_tr_b16 v[40:41], v6 offset:2048
    ds_read_b64_tr_b16 v[42:43], v6 offset:2560
    ds_read_b64_tr_b16 v[44:45], v7 offset:2048
    ds_read_b64_tr_b16 v[46:47], v7 offset:2560
    v_lshlrev_b32 v3, 2, v0
    v_and_b32 v3, 0x7f, v3
    s_waitcnt lgkmcnt(6)
    v_mfma_f32_32x32x16_bf16 v[64:79], v[32:35], a[0:3], 0
    ds_read_b64_tr_b16 v[48:49], v6 offset:4096
    ds_read_b64_tr_b16 v[50:51], v6 offset:4608
    s_waitcnt lgkmcnt(6)
    v_mfma_f32_32x32x16_bf16 v[80:95], v[36:39], a[0:3], 0
    ds_read_b64_tr_b16 v[52:53], v7 offset:4096
    ds_read_b64_tr_b16 v[54:55], v7 offset:4608
    s_waitcnt lgkmcnt(6)
    v_mfma_f32_32x32x16_bf16 v[64:79], v[40:43], a[4:7], v[64:79]
    ds_read_b64_tr_b16 v[56:57], v6 offset:6144
    ds_read_b64_tr_b16 v[58:59], v6 offset:6656
    s_waitcnt lgkmcnt(6)
    v_mfma_f32_32x32x16_bf16 v[80:95], v[44:47], a[4:7], v[80:95]
    ds_read_b64_tr_b16 v[60:61], v7 offset:6144
    ds_read_b64_tr_b16 v[62:63], v7 offset:6656
    s_waitcnt lgkmcnt(6)
    v_mfma_f32_32x32x16_bf16 v[64:79], v[48:51], a[8:11], v[64:79]
    ds_read_b64_tr_b16 v[32:33], v6 offset:8192
    ds_read_b64_tr_b16 v[34:35], v6 offset:8704
    s_waitcnt lgkmcnt(6)
    v_mfma_f32_32x32x16_bf16 v[80:95], v[52:55], a[8:11], v[80:95]
    ds_read_b64_tr_b16 v[36:37], v7 offset:8192
    ds_read_b64_tr_b16 v[38:39], v7 offset:8704
    s_waitcnt lgkmcnt(6)
    v_mfma_f32_32x32x16_bf16 v[64:79], v[56:59], a[12:15], v[64:79]
    ds_read_b64_tr_b16 v[40:41], v6 offset:10240
    ds_read_b64_tr_b16 v[42:43], v6 offset:10752
    s_waitcnt lgkmcnt(6)
    v_mfma_f32_32x32x16_bf16 v[80:95], v[60:63], a[12:15], v[80:95]
    ds_read_b64_tr_b16 v[44:45], v7 offset:10240
    ds_read_b64_tr_b16 v[46:47], v7 offset:10752
    s_waitcnt lgkmcnt(6)
    v_mfma_f32_32x32x16_bf16 v[64:79], v[32:35], a[16:19], v[64:79]
    ds_read_b64_tr_b16 v[48:49], v6 offset:12288
    ds_read_b64_tr_b16 v[50:51], v6 offset:12800
    s_waitcnt lgkmcnt(6)
    v_mfma_f32_32x32x16_bf16 v[80:95], v[36:39], a[16:19], v[80:95]
    ds_read_b64_tr_b16 v[52:53], v7 offset:12288
    ds_read_b64_tr_b16 v[54:55], v7 offset:12800
    s_waitcnt lgkmcnt(6)
    v_mfma_f32_32x32x16_bf16 v[64:79], v[40:43], a[20:23], v[64:79]
    ds_read_b64_tr_b16 v[56:57], v6 offset:14336
    ds_read_b64_tr_b16 v[58:59], v6 offset:14848
    s_waitcnt lgkmcnt(6)
    v_mfma_f32_32x32x16_bf16 v[80:95], v[44:47], a[20:23], v[80:95]
    ds_read_b64_tr_b16 v[60:61], v7 offset:14336
    ds_read_b64_tr_b16 v[62:63], v7 offset:14848
    s_waitcnt lgkmcnt(6)
    v_mfma_f32_32x32x16_bf16 v[64:79], v[48:51], a[24:27], v[64:79]
    ds_read_b64_tr_b16 v[32:33], v8 offset:0
    ds_read_b64_tr_b16 v[34:35], v8 offset:512
    s_waitcnt lgkmcnt(6)
    v_mfma_f32_32x32x16_bf16 v[80:95], v[52:55], a[24:27], v[80:95]
    ds_read_b64_tr_b16 v[36:37], v9 offset:0
    ds_read_b64_tr_b16 v[38:39], v9 offset:512
    s_waitcnt lgkmcnt(6)
    v_mfma_f32_32x32x16_bf16 v[64:79], v[56:59], a[28:31], v[64:79]
    ds_read_b64_tr_b16 v[40:41], v8 offset:2048
    ds_read_b64_tr_b16 v[42:43], v8 offset:2560
    s_waitcnt lgkmcnt(6)
    v_mfma_f32_32x32x16_bf16 v[80:95], v[60:63], a[28:31], v[80:95]
    ds_read_b64_tr_b16 v[44:45], v9 offset:2048
    ds_read_b64_tr_b16 v[46:47], v9 offset:2560
    s_waitcnt lgkmcnt(6)
    v_mfma_f32_32x32x16_bf16 v[64:79], v[32:35], a[32:35], v[64:79]
    ds_read_b64_tr_b16 v[48:49], v8 offset:4096
    ds_read_b64_tr_b16 v[50:51], v8 offset:4608
    s_waitcnt lgkmcnt(6)
    v_mfma_f32_32x32x16_bf16 v[80:95], v[36:39], a[32:35], v[80:95]
    ds_read_b64_tr_b16 v[52:53], v9 offset:4096
    ds_read_b64_tr_b16 v[54:55], v9 offset:4608
    s_waitcnt lgkmcnt(6)
    v_mfma_f32_32x32x16_bf16 v[64:79], v[40:43], a[36:39], v[64:79]
    ds_read_b64_tr_b16 v[56:57], v8 offset:6144
    ds_read_b64_tr_b16 v[58:59], v8 offset:6656
    s_waitcnt lgkmcnt(6)
    v_mfma_f32_32x32x16_bf16 v[80:95], v[44:47], a[36:39], v[80:95]
    ds_read_b64_tr_b16 v[60:61], v9 offset:6144
    ds_read_b64_tr_b16 v[62:63], v9 offset:6656
    s_waitcnt lgkmcnt(6)
    v_mfma_f32_32x32x16_bf16 v[64:79], v[48:51], a[40:43], v[64:79]
    ds_read_b64_tr_b16 v[32:33], v8 offset:8192
    ds_read_b64_tr_b16 v[34:35], v8 offset:8704
    s_waitcnt lgkmcnt(6)
    v_mfma_f32_32x32x16_bf16 v[80:95], v[52:55], a[40:43], v[80:95]
    ds_read_b64_tr_b16 v[36:37], v9 offset:8192
    ds_read_b64_tr_b16 v[38:39], v9 offset:8704
    s_waitcnt lgkmcnt(6)
    v_mfma_f32_32x32x16_bf16 v[64:79], v[56:59], a[44:47], v[64:79]
    ds_read_b64_tr_b16 v[40:41], v8 offset:10240
    ds_read_b64_tr_b16 v[42:43], v8 offset:10752
    s_waitcnt lgkmcnt(6)
    v_mfma_f32_32x32x16_bf16 v[80:95], v[60:63], a[44:47], v[80:95]
    ds_read_b64_tr_b16 v[44:45], v9 offset:10240
    ds_read_b64_tr_b16 v[46:47], v9 offset:10752
    s_cmp_eq_u32 s28, 0
    s_cbranch_scc1 L_hf1_55
    s_waitcnt vmcnt(0)
    s_lshl_b32 s68, s29, 2
    s_add_u32 s68, s68, s71
    s_mov_b64 exec, 1
    s_cmp_eq_u32 s36, 0
    s_cbranch_scc1 L_wt_56
    buffer_store_dword v21, v20, s[52:55], s68 offen
L_wtb_57:
    s_mov_b64 exec, -1
L_hf1_55:
    s_waitcnt lgkmcnt(6)
    v_mfma_f32_32x32x16_bf16 v[64:79], v[32:35], a[48:51], v[64:79]
    ds_read_b64_tr_b16 v[48:49], v8 offset:12288
    ds_read_b64_tr_b16 v[50:51], v8 offset:12800
    s_waitcnt lgkmcnt(6)
    v_mfma_f32_32x32x16_bf16 v[80:95], v[36:39], a[48:51], v[80:95]
    ds_read_b64_tr_b16 v[52:53], v9 offset:12288
    ds_read_b64_tr_b16 v[54:55], v9 offset:12800
    s_waitcnt lgkmcnt(6)
    v_mfma_f32_32x32x16_bf16 v[64:79], v[40:43], a[52:55], v[64:79]
    ds_read_b64_tr_b16 v[56:57], v8 offset:14336
    ds_read_b64_tr_b16 v[58:59], v8 offset:14848
    s_waitcnt lgkmcnt(6)
    v_mfma_f32_32x32x16_bf16 v[80:95], v[44:47], a[52:55], v[80:95]
    ds_read_b64_tr_b16 v[60:61], v9 offset:14336
    ds_read_b64_tr_b16 v[62:63], v9 offset:14848
    v_mov_b32 v14, 10
    s_mov_b64 exec, 1
    ds_write_b32 v11, v14 offset:30736
    s_mov_b64 exec, -1
    s_waitcnt lgkmcnt(7)
    v_mfma_f32_32x32x16_bf16 v[64:79], v[48:51], a[56:59], v[64:79]
    ds_read_b64_tr_b16 v[32:33], v6 offset:16384
    ds_read_b64_tr_b16 v[34:35], v6 offset:16896
    s_waitcnt lgkmcnt(7)
    v_mfma_f32_32x32x16_bf16 v[80:95], v[52:55], a[56:59], v[80:95]
    ds_read_b64_tr_b16 v[36:37], v7 offset:16384
    ds_read_b64_tr_b16 v[38:39], v7 offset:16896
    s_waitcnt lgkmcnt(7)
    v_mfma_f32_32x32x16_bf16 v[64:79], v[56:59], a[60:63], v[64:79]
    ds_read_b64_tr_b16 v[40:41], v6 offset:18432
    ds_read_b64_tr_b16 v[42:43], v6 offset:18944
    s_waitcnt lgkmcnt(7)
    v_mfma_f32_32x32x16_bf16 v[80:95], v[60:63], a[60:63], v[80:95]
    ds_read_b64_tr_b16 v[44:45], v7 offset:18432
    ds_read_b64_tr_b16 v[46:47], v7 offset:18944
    s_waitcnt lgkmcnt(6)
    v_mfma_f32_32x32x16_bf16 v[64:79], v[32:35], a[64:67], v[64:79]
    ds_read_b64_tr_b16 v[48:49], v6 offset:20480
    ds_read_b64_tr_b16 v[50:51], v6 offset:20992
    s_waitcnt lgkmcnt(6)
    v_mfma_f32_32x32x16_bf16 v[80:95], v[36:39], a[64:67], v[80:95]
    ds_read_b64_tr_b16 v[52:53], v7 offset:20480
    ds_read_b64_tr_b16 v[54:55], v7 offset:20992
    s_waitcnt lgkmcnt(6)
    v_mfma_f32_32x32x16_bf16 v[64:79], v[40:43], a[68:71], v[64:79]
    ds_read_b64_tr_b16 v[56:57], v6 offset:22528
    ds_read_b64_tr_b16 v[58:59], v6 offset:23040
    s_waitcnt lgkmcnt(6)
    v_mfma_f32_32x32x16_bf16 v[80:95], v[44:47], a[68:71], v[80:95]
    ds_read_b64_tr_b16 v[60:61], v7 offset:22528
    ds_read_b64_tr_b16 v[62:63], v7 offset:23040
    s_waitcnt lgkmcnt(6)
    v_mfma_f32_32x32x16_bf16 v[64:79], v[48:51], a[72:75], v[64:79]
    ds_read_b64_tr_b16 v[32:33], v6 offset:24576
    ds_read_b64_tr_b16 v[34:35], v6 offset:25088
    s_waitcnt lgkmcnt(6)
    v_mfma_f32_32x32x16_bf16 v[80:95], v[52:55], a[72:75], v[80:95]
    ds_read_b64_tr_b16 v[36:37], v7 offset:24576
    ds_read_b64_tr_b16 v[38:39], v7 offset:25088
    s_waitcnt lgkmcnt(6)
    v_mfma_f32_32x32x16_bf16 v[64:79], v[56:59], a[76:79], v[64:79]
    ds_read_b64_tr_b16 v[40:41], v6 offset:26624
    ds_read_b64_tr_b16 v[42:43], v6 offset:27136
    s_waitcnt lgkmcnt(6)
    v_mfma_f32_32x32x16_bf16 v[80:95], v[60:63], a[76:79], v[80:95]
    ds_read_b64_tr_b16 v[44:45], v7 offset:26624
    ds_read_b64_tr_b16 v[46:47], v7 offset:27136
    s_waitcnt lgkmcnt(6)
    v_mfma_f32_32x32x16_bf16 v[64:79], v[32:35], a[80:83], v[64:79]
    ds_read_b64_tr_b16 v[48:49], v6 offset:28672
    ds_read_b64_tr_b16 v[50:51], v6 offset:29184
    s_waitcnt lgkmcnt(6)
    v_mfma_f32_32x32x16_bf16 v[80:95], v[36:39], a[80:83], v[80:95]
    ds_read_b64_tr_b16 v[52:53], v7 offset:28672
    ds_read_b64_tr_b16 v[54:55], v7 offset:29184
    s_waitcnt lgkmcnt(6)
    v_mfma_f32_32x32x16_bf16 v[64:79], v[40:43], a[84:87], v[64:79]
    ds_read_b64_tr_b16 v[56:57], v6 offset:30720
    ds_read_b64_tr_b16 v[58:59], v6 offset:31232
    s_waitcnt lgkmcnt(6)
    v_mfma_f32_32x32x16_bf16 v[80:95], v[44:47], a[84:87], v[80:95]
    ds_read_b64_tr_b16 v[60:61], v7 offset:30720
    ds_read_b64_tr_b16 v[62:63], v7 offset:31232
    buffer_load_dword v2, v3, s[52:55], s74 offen sc1
    s_waitcnt lgkmcnt(6)
    v_mfma_f32_32x32x16_bf16 v[64:79], v[48:51], a[88:91], v[64:79]
    ds_read_b64_tr_b16 v[32:33], v8 offset:16384
    ds_read_b64_tr_b16 v[34:35], v8 offset:16896
    s_waitcnt lgkmcnt(6)
    v_mfma_f32_32x32x16_bf16 v[80:95], v[52:55], a[88:91], v[80:95]
    ds_read_b64_tr_b16 v[36:37], v9 offset:16384
    ds_read_b64_tr_b16 v[38:39], v9 offset:16896
    s_waitcnt lgkmcnt(6)
    v_mfma_f32_32x32x16_bf16 v[64:79], v[56:59], a[92:95], v[64:79]
    ds_read_b64_tr_b16 v[40:41], v8 offset:18432
    ds_read_b64_tr_b16 v[42:43], v8 offset:18944
    s_waitcnt lgkmcnt(6)
    v_mfma_f32_32x32x16_bf16 v[80:95], v[60:63], a[92:95], v[80:95]
    ds_read_b64_tr_b16 v[44:45], v9 offset:18432
    ds_read_b64_tr_b16 v[46:47], v9 offset:18944
    s_waitcnt lgkmcnt(6)
    v_mfma_f32_32x32x16_bf16 v[64:79], v[32:35], a[96:99], v[64:79]
    ds_read_b64_tr_b16 v[48:49], v8 offset:20480
    ds_read_b64_tr_b16 v[50:51], v8 offset:20992
    s_waitcnt lgkmcnt(6)
    v_mfma_f32_32x32x16_bf16 v[80:95], v[36:39], a[96:99], v[80:95]
    ds_read_b64_tr_b16 v[52:53], v9 offset:20480
    ds_read_b64_tr_b16 v[54:55], v9 offset:20992
    s_waitcnt lgkmcnt(6)
    v_mfma_f32_32x32x16_bf16 v[64:79], v[40:43], a[100:103], v[64:79]
    ds_read_b64_tr_b16 v[56:57], v8 offset:22528
    ds_read_b64_tr_b16 v[58:59], v8 offset:23040
    s_waitcnt lgkmcnt(6)
    v_mfma_f32_32x32x16_bf16 v[80:95], v[44:47], a[100:103], v[80:95]
    ds_read_b64_tr_b16 v[60:61], v9 offset:22528
    ds_read_b64_tr_b16 v[62:63], v9 offset:23040
    s_waitcnt lgkmcnt(6)
    v_mfma_f32_32x32x16_bf16 v[64:79], v[48:51], a[104:107], v[64:79]
    ds_read_b64_tr_b16 v[32:33], v8 offset:24576
    ds_read_b64_tr_b16 v[34:35], v8 offset:25088
    s_waitcnt lgkmcnt(6)
    v_mfma_f32_32x32x16_bf16 v[80:95], v[52:55], a[104:107], v[80:95]
    ds_read_b64_tr_b16 v[36:37], v9 offset:24576
    ds_read_b64_tr_b16 v[38:39], v9 offset:25088
    s_waitcnt lgkmcnt(6)
    v_mfma_f32_32x32x16_bf16 v[64:79], v[56:59], a[108:111], v[64:79]
    ds_read_b64_tr_b16 v[40:41], v8 offset:26624
    ds_read_b64_tr_b16 v[42:43], v8 offset:27136
    s_waitcnt lgkmcnt(6)
    v_mfma_f32_32x32x16_bf16 v[80:95], v[60:63], a[108:111], v[80:95]
    ds_read_b64_tr_b16 v[44:45], v9 offset:26624
    ds_read_b64_tr_b16 v[46:47], v9 offset:27136
    s_waitcnt lgkmcnt(6)
    v_mfma_f32_32x32x16_bf16 v[64:79], v[32:35], a[112:115], v[64:79]
    ds_read_b64_tr_b16 v[48:49], v8 offset:28672
    ds_read_b64_tr_b16 v[50:51], v8 offset:29184
    s_waitcnt lgkmcnt(6)
    v_mfma_f32_32x32x16_bf16 v[80:95], v[36:39], a[112:115], v[80:95]
    ds_read_b64_tr_b16 v[52:53], v9 offset:28672
    ds_read_b64_tr_b16 v[54:55], v9 offset:29184
    s_waitcnt lgkmcnt(6)
    v_mfma_f32_32x32x16_bf16 v[64:79], v[40:43], a[116:119], v[64:79]
    ds_read_b64_tr_b16 v[56:57], v8 offset:30720
    ds_read_b64_tr_b16 v[58:59], v8 offset:31232
    s_waitcnt lgkmcnt(6)
    v_mfma_f32_32x32x16_bf16 v[80:95], v[44:47], a[116:119], v[80:95]
    ds_read_b64_tr_b16 v[60:61], v9 offset:30720
    ds_read_b64_tr_b16 v[62:63], v9 offset:31232
    v_mov_b32 v14, 11
    s_mov_b64 exec, 1
    ds_write_b32 v11, v14 offset:30736
    s_mov_b64 exec, -1
    s_waitcnt lgkmcnt(7)
    v_mfma_f32_32x32x16_bf16 v[64:79], v[48:51], a[120:123], v[64:79]
    ds_read_b64 v[24:25], v22 offset:23552
    ds_read_b64 v[26:27], v22 offset:24064
    s_waitcnt lgkmcnt(7)
    v_mfma_f32_32x32x16_bf16 v[80:95], v[52:55], a[120:123], v[80:95]
    s_waitcnt lgkmcnt(5)
    v_mfma_f32_32x32x16_bf16 v[64:79], v[56:59], a[124:127], v[64:79]
    s_waitcnt lgkmcnt(3)
    v_mfma_f32_32x32x16_bf16 v[80:95], v[60:63], a[124:127], v[80:95]
    s_waitcnt lgkmcnt(0)
    v_mfma_f32_32x32x8_bf16 v[64:79], v[24:25], v[28:29], v[64:79]
    v_mfma_f32_32x32x8_bf16 v[80:95], v[26:27], v[28:29], v[80:95]
    s_cmp_lg_u32 s28, 0
    s_cbranch_scc1 L_C_ffn2
    ds_read_b128 a[112:115], v23 offset:26624
    ds_read_b128 a[116:119], v23 offset:27648
    ds_read_b128 a[120:123], v23 offset:28672
    ds_read_b128 a[124:127], v23 offset:29696
    s_waitcnt vmcnt(0)
    v_cmp_eq_u32 vcc, s34, v2
    s_and_b32 s68, vcc_lo, 255
    s_cmp_eq_u32 s68, 255
    s_cselect_b32 s46, 268435456, 0
    v_cvt_pk_bf16_f32 v64, v64, v65
    v_cvt_pk_bf16_f32 v65, v66, v67
    v_cvt_pk_bf16_f32 v66, v68, v69
    v_cvt_pk_bf16_f32 v67, v70, v71
    v_cvt_pk_bf16_f32 v68, v72, v73
    v_cvt_pk_bf16_f32 v69, v74, v75
    v_cvt_pk_bf16_f32 v70, v76, v77
    v_cvt_pk_bf16_f32 v71, v78, v79
    v_cvt_pk_bf16_f32 v72, v80, v81
    v_cvt_pk_bf16_f32 v73, v82, v83
    v_cvt_pk_bf16_f32 v74, v84, v85
    v_cvt_pk_bf16_f32 v75, v86, v87
    v_cvt_pk_bf16_f32 v76, v88, v89
    v_cvt_pk_bf16_f32 v77, v90, v91
    v_cvt_pk_bf16_f32 v78, v92, v93
    v_cvt_pk_bf16_f32 v79, v94, v95
    s_waitcnt lgkmcnt(0)
    v_mfma_f32_32x32x16_bf16 v[32:47], a[112:115], v[64:67], 0
    v_mfma_f32_32x32x16_bf16 v[80:95], a[116:119], v[68:71], 0
    v_mfma_f32_32x32x16_bf16 v[48:63], a[120:123], v[72:75], 0
    s_add_u32 s68, s3, 0
    s_and_b32 s68, s68, 7
    s_lshl_b32 s68, s68, 13
    s_add_u32 s75, s72, s68
    buffer_load_dwordx4 a[0:3], v1, s[44:47], s75 offen offset:0 sc1
    buffer_load_dwordx4 a[4:7], v1, s[44:47], s75 offen offset:2048 sc1
    s_nop 3
    v_max3_f32 v24, v32, v33, v34
    v_max3_f32 v12, v80, v81, v82
    v_max3_f32 v25, v35, v36, v37
    v_max3_f32 v13, v83, v84, v85
    v_max3_f32 v26, v38, v39, v40
    v_max3_f32 v14, v86, v87, v88
    v_max3_f32 v27, v41, v42, v43
    v_max3_f32 v15, v89, v90, v91
    s_add_u32 s75, s75, 4096
    buffer_load_dwordx4 a[8:11], v1, s[44:47], s75 offen offset:0 sc1
    v_max3_f32 v24, v24, v44, v45
    v_max3_f32 v12, v12, v92, v93
    v_max3_f32 v25, v25, v46, v47
    v_max3_f32 v13, v13, v94, v95
    v_max3_f32 v24, v24, v26, v27
    v_max3_f32 v12, v12, v14, v15
    v_max_f32 v24, v24, v25
    v_max_f32 v12, v12, v13
    buffer_load_dwordx4 a[12:15], v1, s[44:47], s75 offen offset:2048 sc1
    v_mul_f32 v24, v24, v18
    v_mul_f32 v12, v12, v18
    v_pk_fma_f32 v[32:33], v[32:33], v[18:19], v[24:25] op_sel_hi:[1,1,0] neg_lo:[0,0,1] neg_hi:[0,0,1]
    v_pk_fma_f32 v[80:81], v[80:81], v[18:19], v[12:13] op_sel_hi:[1,1,0] neg_lo:[0,0,1] neg_hi:[0,0,1]
    v_pk_fma_f32 v[34:35], v[34:35], v[18:19], v[24:25] op_sel_hi:[1,1,0] neg_lo:[0,0,1] neg_hi:[0,0,1]
    v_pk_fma_f32 v[82:83], v[82:83], v[18:19], v[12:13] op_sel_hi:[1,1,0] neg_lo:[0,0,1] neg_hi:[0,0,1]
    v_pk_fma_f32 v[36:37], v[36:37], v[18:19], v[24:25] op_sel_hi:[1,1,0] neg_lo:[0,0,1] neg_hi:[0,0,1]
    v_pk_fma_f32 v[84:85], v[84:85], v[18:19], v[12:13] op_sel_hi:[1,1,0] neg_lo:[0,0,1] neg_hi:[0,0,1]
    s_add_u32 s68, s3, 1
    s_and_b32 s68, s68, 7
    s_lshl_b32 s68, s68, 13
    s_add_u32 s75, s72, s68
    buffer_load_dwordx4 a[16:19], v1, s[44:47], s75 offen offset:0 sc1
    v_pk_fma_f32 v[38:39], v[38:39], v[18:19], v[24:25] op_sel_hi:[1,1,0] neg_lo:[0,0,1] neg_hi:[0,0,1]
    v_pk_fma_f32 v[86:87], v[86:87], v[18:19], v[12:13] op_sel_hi:[1,1,0] neg_lo:[0,0,1] neg_hi:[0,0,1]
    v_pk_fma_f32 v[40:41], v[40:41], v[18:19], v[24:25] op_sel_hi:[1,1,0] neg_lo:[0,0,1] neg_hi:[0,0,1]
    v_pk_fma_f32 v[88:89], v[88:89], v[18:19], v[12:13] op_sel_hi:[1,1,0] neg_lo:[0,0,1] neg_hi:[0,0,1]
    v_pk_fma_f32 v[42:43], v[42:43], v[18:19], v[24:25] op_sel_hi:[1,1,0] neg_lo:[0,0,1] neg_hi:[0,0,1]
    v_pk_fma_f32 v[90:91], v[90:91], v[18:19], v[12:13] op_sel_hi:[1,1,0] neg_lo:[0,0,1] neg_hi:[0,0,1]
    v_pk_fma_f32 v[44:45], v[44:45], v[18:19], v[24:25] op_sel_hi:[1,1,0] neg_lo:[0,0,1] neg_hi:[0,0,1]
    v_pk_fma_f32 v[92:93], v[92:93], v[18:19], v[12:13] op_sel_hi:[1,1,0] neg_lo:[0,0,1] neg_hi:[0,0,1]
    buffer_load_dwordx4 a[20:23], v1, s[44:47], s75 offen offset:2048 sc1
    v_pk_fma_f32 v[46:47], v[46:47], v[18:19], v[24:25] op_sel_hi:[1,1,0] neg_lo:[0,0,1] neg_hi:[0,0,1]
    v_pk_fma_f32 v[94:95], v[94:95], v[18:19], v[12:13] op_sel_hi:[1,1,0] neg_lo:[0,0,1] neg_hi:[0,0,1]
    v_exp_f32 v32, v32
    v_exp_f32 v80, v80
    v_exp_f32 v33, v33
    v_exp_f32 v81, v81
    v_exp_f32 v34, v34
    v_exp_f32 v82, v82
    s_add_u32 s75, s75, 4096
    buffer_load_dwordx4 a[24:27], v1, s[44:47], s75 offen offset:0 sc1
    v_exp_f32 v35, v35
    v_exp_f32 v83, v83
    v_exp_f32 v36, v36
    v_exp_f32 v84, v84
    v_exp_f32 v37, v37
    v_exp_f32 v85, v85
    v_exp_f32 v38, v38
    v_exp_f32 v86, v86
    buffer_load_dwordx4 a[28:31], v1, s[44:47], s75 offen offset:2048 sc1
    v_exp_f32 v39, v39
    v_exp_f32 v87, v87
    v_exp_f32 v40, v40
    v_exp_f32 v88, v88
    v_exp_f32 v41, v41
    v_exp_f32 v89, v89
    v_exp_f32 v42, v42
    v_exp_f32 v90, v90
    s_add_u32 s68, s3, 2
    s_and_b32 s68, s68, 7
    s_lshl_b32 s68, s68, 13
    s_add_u32 s75, s72, s68
    buffer_load_dwordx4 a[32:35], v1, s[44:47], s75 offen offset:0 sc1
    v_exp_f32 v43, v43
    v_exp_f32 v91, v91
    v_exp_f32 v44, v44
    v_exp_f32 v92, v92
    v_exp_f32 v45, v45
    v_exp_f32 v93, v93
    v_exp_f32 v46, v46
    v_exp_f32 v94, v94
    buffer_load_dwordx4 a[36:39], v1, s[44:47], s75 offen offset:2048 sc1
    v_exp_f32 v47, v47
    v_exp_f32 v95, v95
    v_pk_add_f32 v[24:25], v[32:33], v[34:35]
    v_pk_add_f32 v[12:13], v[80:81], v[82:83]
    v_pk_add_f32 v[26:27], v[36:37], v[38:39]
    v_pk_add_f32 v[14:15], v[84:85], v[86:87]
    v_pk_add_f32 v[24:25], v[24:25], v[40:41]
    v_pk_add_f32 v[12:13], v[12:13], v[88:89]
    s_add_u32 s75, s75, 4096
    buffer_load_dwordx4 a[40:43], v1, s[44:47], s75 offen offset:0 sc1
    v_pk_add_f32 v[26:27], v[26:27], v[42:43]
    v_pk_add_f32 v[14:15], v[14:15], v[90:91]
    v_pk_add_f32 v[24:25], v[24:25], v[44:45]
    v_pk_add_f32 v[12:13], v[12:13], v[92:93]
    v_pk_add_f32 v[26:27], v[26:27], v[46:47]
    v_pk_add_f32 v[14:15], v[14:15], v[94:95]
    v_pk_add_f32 v[24:25], v[24:25], v[26:27]
    v_pk_add_f32 v[12:13], v[12:13], v[14:15]
    buffer_load_dwordx4 a[44:47], v1, s[44:47], s75 offen offset:2048 sc1
    v_add_f32 v24, v24, v25
    v_add_f32 v12, v12, v13
    v_rcp_f32 v24, v24
    v_rcp_f32 v12, v12
    s_nop 0
    v_pk_mul_f32 v[32:33], v[32:33], v[24:25] op_sel_hi:[1,0]
    v_pk_mul_f32 v[80:81], v[80:81], v[12:13] op_sel_hi:[1,0]
    v_pk_mul_f32 v[34:35], v[34:35], v[24:25] op_sel_hi:[1,0]
    v_pk_mul_f32 v[82:83], v[82:83], v[12:13] op_sel_hi:[1,0]
    s_add_u32 s68, s3, 3
    s_and_b32 s68, s68, 7
    s_lshl_b32 s68, s68, 13
    s_add_u32 s75, s72, s68
    buffer_load_dwordx4 a[48:51], v1, s[44:47], s75 offen offset:0 sc1
    v_pk_mul_f32 v[36:37], v[36:37], v[24:25] op_sel_hi:[1,0]
    v_pk_mul_f32 v[84:85], v[84:85], v[12:13] op_sel_hi:[1,0]
    v_pk_mul_f32 v[38:39], v[38:39], v[24:25] op_sel_hi:[1,0]
    v_pk_mul_f32 v[86:87], v[86:87], v[12:13] op_sel_hi:[1,0]
    v_pk_mul_f32 v[40:41], v[40:41], v[24:25] op_sel_hi:[1,0]
    v_pk_mul_f32 v[88:89], v[88:89], v[12:13] op_sel_hi:[1,0]
    v_pk_mul_f32 v[42:43], v[42:43], v[24:25] op_sel_hi:[1,0]
    v_pk_mul_f32 v[90:91], v[90:91], v[12:13] op_sel_hi:[1,0]
    buffer_load_dwordx4 a[52:55], v1, s[44:47], s75 offen offset:2048 sc1
    v_pk_mul_f32 v[44:45], v[44:45], v[24:25] op_sel_hi:[1,0]
    v_pk_mul_f32 v[92:93], v[92:93], v[12:13] op_sel_hi:[1,0]
    v_pk_mul_f32 v[46:47], v[46:47], v[24:25] op_sel_hi:[1,0]
    v_pk_mul_f32 v[94:95], v[94:95], v[12:13] op_sel_hi:[1,0]
    v_cvt_pk_bf16_f32 v96, v32, v33
    v_cvt_pk_bf16_f32 v104, v80, v81
    v_cvt_pk_bf16_f32 v97, v34, v35
    v_cvt_pk_bf16_f32 v105, v82, v83
    s_add_u32 s75, s75, 4096
    buffer_load_dwordx4 a[56:59], v1, s[44:47], s75 offen offset:0 sc1
    v_cvt_pk_bf16_f32 v98, v36, v37
    v_cvt_pk_bf16_f32 v106, v84, v85
    v_cvt_pk_bf16_f32 v99, v38, v39
    v_cvt_pk_bf16_f32 v107, v86, v87
    v_cvt_pk_bf16_f32 v100, v40, v41
    v_cvt_pk_bf16_f32 v108, v88, v89
    v_cvt_pk_bf16_f32 v101, v42, v43
    v_cvt_pk_bf16_f32 v109, v90, v91
    v_cvt_pk_bf16_f32 v102, v44, v45
    v_cvt_pk_bf16_f32 v110, v92, v93
    v_cvt_pk_bf16_f32 v103, v46, v47
    v_cvt_pk_bf16_f32 v111, v94, v95
    v_mfma_f32_32x32x16_bf16 v[32:47], a[124:127], v[76:79], 0
    s_nop 10
    v_max3_f32 v24, v48, v49, v50
    v_max3_f32 v12, v32, v33, v34
    v_max3_f32 v25, v51, v52, v53
    v_max3_f32 v13, v35, v36, v37
    v_max3_f32 v26, v54, v55, v56
    v_max3_f32 v14, v38, v39, v40
    v_max3_f32 v27, v57, v58, v59
    v_max3_f32 v15, v41, v42, v43
    buffer_load_dwordx4 a[60:63], v1, s[44:47], s75 offen offset:2048 sc1
    v_max3_f32 v24, v24, v60, v61
    v_max3_f32 v12, v12, v44, v45
    v_max3_f32 v25, v25, v62, v63
    v_max3_f32 v13, v13, v46, v47
    v_max3_f32 v24, v24, v26, v27
    v_max3_f32 v12, v12, v14, v15
    v_max_f32 v24, v24, v25
    v_max_f32 v12, v12, v13
    s_add_u32 s68, s3, 4
    s_and_b32 s68, s68, 7
    s_lshl_b32 s68, s68, 13
    s_add_u32 s75, s72, s68
    buffer_load_dwordx4 a[64:67], v1, s[44:47], s75 offen offset:0 sc1
    v_mul_f32 v24, v24, v18
    v_mul_f32 v12, v12, v18
    v_pk_fma_f32 v[48:49], v[48:49], v[18:19], v[24:25] op_sel_hi:[1,1,0] neg_lo:[0,0,1] neg_hi:[0,0,1]
    v_pk_fma_f32 v[32:33], v[32:33], v[18:19], v[12:13] op_sel_hi:[1,1,0] neg_lo:[0,0,1] neg_hi:[0,0,1]
    v_pk_fma_f32 v[50:51], v[50:51], v[18:19], v[24:25] op_sel_hi:[1,1,0] neg_lo:[0,0,1] neg_hi:[0,0,1]
    v_pk_fma_f32 v[34:35], v[34:35], v[18:19], v[12:13] op_sel_hi:[1,1,0] neg_lo:[0,0,1] neg_hi:[0,0,1]
    v_pk_fma_f32 v[52:53], v[52:53], v[18:19], v[24:25] op_sel_hi:[1,1,0] neg_lo:[0,0,1] neg_hi:[0,0,1]
    v_pk_fma_f32 v[36:37], v[36:37], v[18:19], v[12:13] op_sel_hi:[1,1,0] neg_lo:[0,0,1] neg_hi:[0,0,1]
    buffer_load_dwordx4 a[68:71], v1, s[44:47], s75 offen offset:2048 sc1
    v_pk_fma_f32 v[54:55], v[54:55], v[18:19], v[24:25] op_sel_hi:[1,1,0] neg_lo:[0,0,1] neg_hi:[0,0,1]
    v_pk_fma_f32 v[38:39], v[38:39], v[18:19], v[12:13] op_sel_hi:[1,1,0] neg_lo:[0,0,1] neg_hi:[0,0,1]
    v_pk_fma_f32 v[56:57], v[56:57], v[18:19], v[24:25] op_sel_hi:[1,1,0] neg_lo:[0,0,1] neg_hi:[0,0,1]
    v_pk_fma_f32 v[40:41], v[40:41], v[18:19], v[12:13] op_sel_hi:[1,1,0] neg_lo:[0,0,1] neg_hi:[0,0,1]
    v_pk_fma_f32 v[58:59], v[58:59], v[18:19], v[24:25] op_sel_hi:[1,1,0] neg_lo:[0,0,1] neg_hi:[0,0,1]
    v_pk_fma_f32 v[42:43], v[42:43], v[18:19], v[12:13] op_sel_hi:[1,1,0] neg_lo:[0,0,1] neg_hi:[0,0,1]
    v_pk_fma_f32 v[60:61], v[60:61], v[18:19], v[24:25] op_sel_hi:[1,1,0] neg_lo:[0,0,1] neg_hi:[0,0,1]
    v_pk_fma_f32 v[44:45], v[44:45], v[18:19], v[12:13] op_sel_hi:[1,1,0] neg_lo:[0,0,1] neg_hi:[0,0,1]
    s_add_u32 s75, s75, 4096
    buffer_load_dwordx4 a[72:75], v1, s[44:47], s75 offen offset:0 sc1
    v_pk_fma_f32 v[62:63], v[62:63], v[18:19], v[24:25] op_sel_hi:[1,1,0] neg_lo:[0,0,1] neg_hi:[0,0,1]
    v_pk_fma_f32 v[46:47], v[46:47], v[18:19], v[12:13] op_sel_hi:[1,1,0] neg_lo:[0,0,1] neg_hi:[0,0,1]
    v_exp_f32 v48, v48
    v_exp_f32 v32, v32
    v_exp_f32 v49, v49
    v_exp_f32 v33, v33
    v_exp_f32 v50, v50
    v_exp_f32 v34, v34
    buffer_load_dwordx4 a[76:79], v1, s[44:47], s75 offen offset:2048 sc1
    v_exp_f32 v51, v51
    v_exp_f32 v35, v35
    v_exp_f32 v52, v52
    v_exp_f32 v36, v36
    v_exp_f32 v53, v53
    v_exp_f32 v37, v37
    v_exp_f32 v54, v54
    v_exp_f32 v38, v38
    s_add_u32 s68, s3, 5
    s_and_b32 s68, s68, 7
    s_lshl_b32 s68, s68, 13
    s_add_u32 s75, s72, s68
    buffer_load_dwordx4 a[80:83], v1, s[44:47], s75 offen offset:0 sc1
    v_exp_f32 v55, v55
    v_exp_f32 v39, v39
    v_exp_f32 v56, v56
    v_exp_f32 v40, v40
    v_exp_f32 v57, v57
    v_exp_f32 v41, v41
    v_exp_f32 v58, v58
    v_exp_f32 v42, v42
    buffer_load_dwordx4 a[84:87], v1, s[44:47], s75 offen offset:2048 sc1
    v_exp_f32 v59, v59
    v_exp_f32 v43, v43
    v_exp_f32 v60, v60
    v_exp_f32 v44, v44
    v_exp_f32 v61, v61
    v_exp_f32 v45, v45
    v_exp_f32 v62, v62
    v_exp_f32 v46, v46
    s_add_u32 s75, s75, 4096
    buffer_load_dwordx4 a[88:91], v1, s[44:47], s75 offen offset:0 sc1
    v_mov_b32 v28, 12
    ds_write_b32 v11, v28 offset:30736
    v_exp_f32 v63, v63
    v_exp_f32 v47, v47
    v_pk_add_f32 v[24:25], v[48:49], v[50:51]
    v_pk_add_f32 v[12:13], v[32:33], v[34:35]
    v_pk_add_f32 v[26:27], v[52:53], v[54:55]
    v_pk_add_f32 v[14:15], v[36:37], v[38:39]
    v_pk_add_f32 v[24:25], v[24:25], v[56:57]
    v_pk_add_f32 v[12:13], v[12:13], v[40:41]
    buffer_load_dwordx4 a[92:95], v1, s[44:47], s75 offen offset:2048 sc1
    v_pk_add_f32 v[26:27], v[26:27], v[58:59]
    v_pk_add_f32 v[14:15], v[14:15], v[42:43]
    v_pk_add_f32 v[24:25], v[24:25], v[60:61]
    v_pk_add_f32 v[12:13], v[12:13], v[44:45]
    v_pk_add_f32 v[26:27], v[26:27], v[62:63]
    v_pk_add_f32 v[14:15], v[14:15], v[46:47]
    v_pk_add_f32 v[24:25], v[24:25], v[26:27]
    v_pk_add_f32 v[12:13], v[12:13], v[14:15]
    s_add_u32 s68, s3, 6
    s_and_b32 s68, s68, 7
    s_lshl_b32 s68, s68, 13
    s_add_u32 s75, s72, s68
    buffer_load_dwordx4 a[96:99], v1, s[44:47], s75 offen offset:0 sc1
    v_add_f32 v24, v24, v25
    v_add_f32 v12, v12, v13
    v_rcp_f32 v24, v24
    v_rcp_f32 v12, v12
    s_nop 0
    v_pk_mul_f32 v[48:49], v[48:49], v[24:25] op_sel_hi:[1,0]
    v_pk_mul_f32 v[32:33], v[32:33], v[12:13] op_sel_hi:[1,0]
    v_pk_mul_f32 v[50:51], v[50:51], v[24:25] op_sel_hi:[1,0]
    v_pk_mul_f32 v[34:35], v[34:35], v[12:13] op_sel_hi:[1,0]
    buffer_load_dwordx4 a[100:103], v1, s[44:47], s75 offen offset:2048 sc1
    v_pk_mul_f32 v[52:53], v[52:53], v[24:25] op_sel_hi:[1,0]
    v_pk_mul_f32 v[36:37], v[36:37], v[12:13] op_sel_hi:[1,0]
    v_pk_mul_f32 v[54:55], v[54:55], v[24:25] op_sel_hi:[1,0]
    v_pk_mul_f32 v[38:39], v[38:39], v[12:13] op_sel_hi:[1,0]
    v_pk_mul_f32 v[56:57], v[56:57], v[24:25] op_sel_hi:[1,0]
    v_pk_mul_f32 v[40:41], v[40:41], v[12:13] op_sel_hi:[1,0]
    v_pk_mul_f32 v[58:59], v[58:59], v[24:25] op_sel_hi:[1,0]
    v_pk_mul_f32 v[42:43], v[42:43], v[12:13] op_sel_hi:[1,0]
    s_add_u32 s75, s75, 4096
    buffer_load_dwordx4 a[104:107], v1, s[44:47], s75 offen offset:0 sc1
    v_pk_mul_f32 v[60:61], v[60:61], v[24:25] op_sel_hi:[1,0]
    v_pk_mul_f32 v[44:45], v[44:45], v[12:13] op_sel_hi:[1,0]
    v_pk_mul_f32 v[62:63], v[62:63], v[24:25] op_sel_hi:[1,0]
    v_pk_mul_f32 v[46:47], v[46:47], v[12:13] op_sel_hi:[1,0]
    v_cvt_pk_bf16_f32 v112, v48, v49
    v_cvt_pk_bf16_f32 v120, v32, v33
    v_cvt_pk_bf16_f32 v113, v50, v51
    v_cvt_pk_bf16_f32 v121, v34, v35
    buffer_load_dwordx4 a[108:111], v1, s[44:47], s75 offen offset:2048 sc1
    v_cvt_pk_bf16_f32 v114, v52, v53
    v_cvt_pk_bf16_f32 v122, v36, v37
    v_cvt_pk_bf16_f32 v115, v54, v55
    v_cvt_pk_bf16_f32 v123, v38, v39
    v_cvt_pk_bf16_f32 v116, v56, v57
    v_cvt_pk_bf16_f32 v124, v40, v41
    v_cvt_pk_bf16_f32 v117, v58, v59
    v_cvt_pk_bf16_f32 v125, v42, v43
    v_cvt_pk_bf16_f32 v118, v60, v61
    v_cvt_pk_bf16_f32 v126, v44, v45
    v_cvt_pk_bf16_f32 v119, v62, v63
    v_cvt_pk_bf16_f32 v127, v46, v47
    s_cmp_lg_u32 s46, 0
    s_cbranch_scc1 L_C_p2b
    s_branch L_C_p2
L_C_ffn2:
    s_min_u32 s68, s29, 3
    s_add_u32 s68, s68, s29
    s_lshl_b32 s68, s68, 11
    s_add_u32 s69, s70, s68
    s_add_u32 s69, s69, 65536
    s_nop 3
    v_max_f32 v64, 0, v64
    v_max_f32 v65, 0, v65
    v_max_f32 v66, 0, v66
    v_max_f32 v67, 0, v67
    v_max_f32 v68, 0, v68
    v_max_f32 v69, 0, v69
    v_max_f32 v70, 0, v70
    v_max_f32 v71, 0, v71
    v_max_f32 v72, 0, v72
    v_max_f32 v73, 0, v73
    v_max_f32 v74, 0, v74
    v_max_f32 v75, 0, v75
    v_max_f32 v76, 0, v76
    v_max_f32 v77, 0, v77
    v_max_f32 v78, 0, v78
    v_max_f32 v79, 0, v79
    v_pk_mul_f32 v[64:65], v[64:65], v[16:17]
    v_pk_mul_f32 v[66:67], v[66:67], v[16:17]
    v_pk_mul_f32 v[68:69], v[68:69], v[16:17]
    v_pk_mul_f32 v[70:71], v[70:71], v[16:17]
    v_pk_mul_f32 v[72:73], v[72:73], v[16:17]
    v_pk_mul_f32 v[74:75], v[74:75], v[16:17]
    v_pk_mul_f32 v[76:77], v[76:77], v[16:17]
    v_pk_mul_f32 v[78:79], v[78:79], v[16:17]
    v_pk_mul_f32 v[64:65], v[64:65], v[64:65]
    v_pk_mul_f32 v[66:67], v[66:67], v[66:67]
    v_pk_mul_f32 v[68:69], v[68:69], v[68:69]
    v_pk_mul_f32 v[70:71], v[70:71], v[70:71]
    v_pk_mul_f32 v[72:73], v[72:73], v[72:73]
    v_pk_mul_f32 v[74:75], v[74:75], v[74:75]
    v_pk_mul_f32 v[76:77], v[76:77], v[76:77]
    v_pk_mul_f32 v[78:79], v[78:79], v[78:79]
    v_cvt_pk_bf16_f32 v64, v64, v65
    v_cvt_pk_bf16_f32 v65, v66, v67
    v_cvt_pk_bf16_f32 v66, v68, v69
    v_cvt_pk_bf16_f32 v67, v70, v71
    v_cvt_pk_bf16_f32 v68, v72, v73
    v_cvt_pk_bf16_f32 v69, v74, v75
    v_cvt_pk_bf16_f32 v70, v76, v77
    v_cvt_pk_bf16_f32 v71, v78, v79
    s_cmp_eq_u32 s36, 0
    s_cbranch_scc1 L_wt_58
    buffer_store_dwordx4 v[64:67], v1, s[52:55], s69 offen
    buffer_store_dwordx4 v[68:71], v1, s[52:55], s69 offen offset:1024
L_wtb_59:
    s_cmp_ge_u32 s29, 3
    s_cbranch_scc1 L_one_60
    s_add_u32 s69, s69, 2048
    v_max_f32 v80, 0, v80
    v_max_f32 v81, 0, v81
    v_max_f32 v82, 0, v82
    v_max_f32 v83, 0, v83
    v_max_f32 v84, 0, v84
    v_max_f32 v85, 0, v85
    v_max_f32 v86, 0, v86
    v_max_f32 v87, 0, v87
    v_max_f32 v88, 0, v88
    v_max_f32 v89, 0, v89
    v_max_f32 v90, 0, v90
    v_max_f32 v91, 0, v91
    v_max_f32 v92, 0, v92
    v_max_f32 v93, 0, v93
    v_max_f32 v94, 0, v94
    v_max_f32 v95, 0, v95
    v_pk_mul_f32 v[80:81], v[80:81], v[16:17]
    v_pk_mul_f32 v[82:83], v[82:83], v[16:17]
    v_pk_mul_f32 v[84:85], v[84:85], v[16:17]
    v_pk_mul_f32 v[86:87], v[86:87], v[16:17]
    v_pk_mul_f32 v[88:89], v[88:89], v[16:17]
    v_pk_mul_f32 v[90:91], v[90:91], v[16:17]
    v_pk_mul_f32 v[92:93], v[92:93], v[16:17]
    v_pk_mul_f32 v[94:95], v[94:95], v[16:17]
    v_pk_mul_f32 v[80:81], v[80:81], v[80:81]
    v_pk_mul_f32 v[82:83], v[82:83], v[82:83]
    v_pk_mul_f32 v[84:85], v[84:85], v[84:85]
    v_pk_mul_f32 v[86:87], v[86:87], v[86:87]
    v_pk_mul_f32 v[88:89], v[88:89], v[88:89]
    v_pk_mul_f32 v[90:91], v[90:91], v[90:91]
    v_pk_mul_f32 v[92:93], v[92:93], v[92:93]
    v_pk_mul_f32 v[94:95], v[94:95], v[94:95]
    v_cvt_pk_bf16_f32 v80, v80, v81
    v_cvt_pk_bf16_f32 v81, v82, v83
    v_cvt_pk_bf16_f32 v82, v84, v85
    v_cvt_pk_bf16_f32 v83, v86, v87
    v_cvt_pk_bf16_f32 v84, v88, v89
    v_cvt_pk_bf16_f32 v85, v90, v91
    v_cvt_pk_bf16_f32 v86, v92, v93
    v_cvt_pk_bf16_f32 v87, v94, v95
    s_cmp_eq_u32 s36, 0
    s_cbranch_scc1 L_wt_61
    buffer_store_dwordx4 v[80:83], v1, s[52:55], s69 offen
    buffer_store_dwordx4 v[84:87], v1, s[52:55], s69 offen offset:1024
L_wtb_62:
L_one_60:
    s_waitcnt vmcnt(2)
L_C_p2:
    s_mov_b32 s64, 0
L_fs_63:
    v_cmp_eq_u32 vcc, s34, v2
    s_and_b32 s68, vcc_lo, 255
    s_cmp_eq_u32 s68, 255
    s_cbranch_scc1 L_fsd_64
    s_add_u32 s64, s64, 1
    s_cmp_gt_u32 s64, 100000
    s_cbranch_scc1 L_fsd_64
    s_sleep 2
    buffer_load_dword v2, v3, s[52:55], s74 offen sc1
    s_waitcnt vmcnt(0)
    s_branch L_fs_63
L_fsd_64:
    s_add_u32 s68, s3, 0
    s_and_b32 s68, s68, 7
    s_lshl_b32 s68, s68, 13
    s_add_u32 s75, s72, s68
    buffer_load_dwordx4 a[0:3], v1, s[52:55], s75 offen offset:0 sc1
    buffer_load_dwordx4 a[4:7], v1, s[52:55], s75 offen offset:2048 sc1
    s_add_u32 s75, s75, 4096
    buffer_load_dwordx4 a[8:11], v1, s[52:55], s75 offen offset:0 sc1
    buffer_load_dwordx4 a[12:15], v1, s[52:55], s75 offen offset:2048 sc1
    s_add_u32 s68, s3, 1
    s_and_b32 s68, s68, 7
    s_lshl_b32 s68, s68, 13
    s_add_u32 s75, s72, s68
    buffer_load_dwordx4 a[16:19], v1, s[52:55], s75 offen offset:0 sc1
    buffer_load_dwordx4 a[20:23], v1, s[52:55], s75 offen offset:2048 sc1
    s_add_u32 s75, s75, 4096
    buffer_load_dwordx4 a[24:27], v1, s[52:55], s75 offen offset:0 sc1
    buffer_load_dwordx4 a[28:31], v1, s[52:55], s75 offen offset:2048 sc1
    s_cmp_eq_u32 s28, 0
    s_cbranch_scc1 L_hf2_65
    s_waitcnt vmcnt(8)
    s_lshl_b32 s68, s29, 2
    s_add_u32 s68, s68, s71
    s_add_u32 s68, s68, 32
    s_mov_b64 exec, 1
    s_cmp_eq_u32 s36, 0
    s_cbranch_scc1 L_wt_66
    buffer_store_dword v21, v20, s[52:55], s68 offen
L_wtb_67:
    s_mov_b64 exec, -1
L_hf2_65:
    s_add_u32 s68, s3, 2
    s_and_b32 s68, s68, 7
    s_lshl_b32 s68, s68, 13
    s_add_u32 s75, s72, s68
    buffer_load_dwordx4 a[32:35], v1, s[52:55], s75 offen offset:0 sc1
    buffer_load_dwordx4 a[36:39], v1, s[52:55], s75 offen offset:2048 sc1
    s_add_u32 s75, s75, 4096
    buffer_load_dwordx4 a[40:43], v1, s[52:55], s75 offen offset:0 sc1
    buffer_load_dwordx4 a[44:47], v1, s[52:55], s75 offen offset:2048 sc1
    s_add_u32 s68, s3, 3
    s_and_b32 s68, s68, 7
    s_lshl_b32 s68, s68, 13
    s_add_u32 s75, s72, s68
    buffer_load_dwordx4 a[48:51], v1, s[52:55], s75 offen offset:0 sc1
    buffer_load_dwordx4 a[52:55], v1, s[52:55], s75 offen offset:2048 sc1
    s_add_u32 s75, s75, 4096
    buffer_load_dwordx4 a[56:59], v1, s[52:55], s75 offen offset:0 sc1
    buffer_load_dwordx4 a[60:63], v1, s[52:55], s75 offen offset:2048 sc1
    s_add_u32 s68, s3, 4
    s_and_b32 s68, s68, 7
    s_lshl_b32 s68, s68, 13
    s_add_u32 s75, s72, s68
    buffer_load_dwordx4 a[64:67], v1, s[52:55], s75 offen offset:0 sc1
    buffer_load_dwordx4 a[68:71], v1, s[52:55], s75 offen offset:2048 sc1
    s_add_u32 s75, s75, 4096
    buffer_load_dwordx4 a[72:75], v1, s[52:55], s75 offen offset:0 sc1
    buffer_load_dwordx4 a[76:79], v1, s[52:55], s75 offen offset:2048 sc1
    s_add_u32 s68, s3, 5
    s_and_b32 s68, s68, 7
    s_lshl_b32 s68, s68, 13
    s_add_u32 s75, s72, s68
    buffer_load_dwordx4 a[80:83], v1, s[52:55], s75 offen offset:0 sc1
    buffer_load_dwordx4 a[84:87], v1, s[52:55], s75 offen offset:2048 sc1
    s_add_u32 s75, s75, 4096
    buffer_load_dwordx4 a[88:91], v1, s[52:55], s75 offen offset:0 sc1
    buffer_load_dwordx4 a[92:95], v1, s[52:55], s75 offen offset:2048 sc1
    s_add_u32 s68, s3, 6
    s_and_b32 s68, s68, 7
    s_lshl_b32 s68, s68, 13
    s_add_u32 s75, s72, s68
    buffer_load_dwordx4 a[96:99], v1, s[52:55], s75 offen offset:0 sc1
    buffer_load_dwordx4 a[100:103], v1, s[52:55], s75 offen offset:2048 sc1
    s_add_u32 s75, s75, 4096
    buffer_load_dwordx4 a[104:107], v1, s[52:55], s75 offen offset:0 sc1
    buffer_load_dwordx4 a[108:111], v1, s[52:55], s75 offen offset:2048 sc1
L_C_p2b:
    buffer_load_dword v2, v3, s[52:55], s74 offen sc1
    s_and_b32 s69, s33, 1
    s_lshl_b32 s69, s69, 6
    v_mov_b32 v13, v10
    v_mov_b32 v14, v11
    v_bfe_u32 v10, v0, 2, 2
    v_lshrrev_b32 v11, 5, v0
    v_lshl_add_u32 v11, v11, 2, v10
    v_lshlrev_b32 v11, 7, v11
    v_bfe_u32 v12, v0, 4, 1
    v_lshl_add_u32 v11, v12, 5, v11
    v_and_b32 v12, 3, v0
    v_lshl_add_u32 v11, v12, 3, v11
    v_lshrrev_b32 v10, 1, v10
    v_xor_b32 v10, 0, v10
    v_lshl_add_u32 v4, v10, 6, v11
    v_mov_b32 v10, v13
    v_mov_b32 v11, v14
    s_and_b32 s68, s33, 1
    s_lshl_b32 s68, s68, 11
    v_add_u32 v4, s68, v4
    v_add_u32 v5, 0x10000, v4
    v_xor_b32 v6, 64, v4
    v_add_u32 v7, 0x10000, v6
    v_and_b32 v12, 31, v0
    s_lshr_b32 s68, s33, 1
    s_lshl_b32 s68, s68, 5
    v_add_u32 v12, s68, v12
    v_lshrrev_b32 v13, 5, v0
    v_lshlrev_b32 v8, 7, v12
    v_lshl_add_u32 v8, v13, 3, v8
    v_add_u32 v8, s69, v8
    v_add_u32 v8, 139264, v8
    v_lshlrev_b32 v9, 10, v12
    v_lshl_add_u32 v9, v13, 4, v9
    v_add_u32 v9, s69, v9
    v_lshlrev_b32 v15, 3, v13
    v_add_u32 v15, s69, v15
    v_add_u32 v15, 147456, v15
    s_lshl_b32 s68, s31, 16
    s_lshl_b32 s69, s32, 7
    s_add_u32 s66, s68, s69
    v_and_b32 v12, 0x2f, v0
    v_lshlrev_b32 v12, 4, v12
    v_add_u32 v12, 131072, v12
    v_lshlrev_b32 v16, 5, v13
    v_add_u32 v16, 135168, v16
    v_bfe_u32 v13, v0, 4, 1
    v_cmp_eq_u32 vcc, 1, v13
    v_add_u32 v14, 256, v12
    v_add_u32 v13, 16, v16
    v_cndmask_b32 v28, v12, v16, vcc
    v_cndmask_b32 v29, v14, v13, vcc
    v_mov_b32 v12, 0x400
    v_cndmask_b32 v30, v12, 64, vcc
    s_lshl_b32 s68, s29, 12
    s_add_u32 s73, s68, s70
    s_add_u32 s73, s73, 90112
    s_mov_b32 s64, 0
L_sp_68:
    ds_read_b64 v[12:13], v10 offset:30720
    s_waitcnt lgkmcnt(0)
    v_min_u32 v12, v12, v13
    s_nop 0
    v_readfirstlane_b32 s65, v12
    s_add_u32 s64, s64, 1
    s_cmp_ge_u32 s65, 11
    s_cbranch_scc1 L_spd_70
    s_cmp_lt_u32 s64, 400000
    s_cbranch_scc1 L_sp_68
L_spd_70:
    ds_read_b64_tr_b16 v[32:33], v4 offset:32768
    ds_read_b64_tr_b16 v[34:35], v4 offset:33792
    ds_read_b64_tr_b16 v[36:37], v6 offset:32768
    ds_read_b64_tr_b16 v[38:39], v6 offset:33792
    ds_read_b64_tr_b16 v[40:41], v4 offset:36864
    ds_read_b64_tr_b16 v[42:43], v4 offset:37888
    ds_read_b64_tr_b16 v[44:45], v6 offset:36864
    ds_read_b64_tr_b16 v[46:47], v6 offset:37888
    s_waitcnt vmcnt(25)
    s_waitcnt lgkmcnt(6)
    v_mfma_f32_32x32x16_bf16 v[64:79], v[32:35], a[0:3], 0
    ds_read_b64_tr_b16 v[48:49], v4 offset:40960
    ds_read_b64_tr_b16 v[50:51], v4 offset:41984
    s_waitcnt lgkmcnt(6)
    v_mfma_f32_32x32x16_bf16 v[80:95], v[36:39], a[0:3], 0
    ds_read_b64_tr_b16 v[52:53], v6 offset:40960
    ds_read_b64_tr_b16 v[54:55], v6 offset:41984
    s_waitcnt lgkmcnt(6)
    v_mfma_f32_32x32x16_bf16 v[64:79], v[40:43], a[4:7], v[64:79]
    ds_read_b64_tr_b16 v[32:33], v4 offset:45056
    ds_read_b64_tr_b16 v[34:35], v4 offset:46080
    s_waitcnt lgkmcnt(6)
    v_mfma_f32_32x32x16_bf16 v[80:95], v[44:47], a[4:7], v[80:95]
    ds_read_b64_tr_b16 v[36:37], v6 offset:45056
    ds_read_b64_tr_b16 v[38:39], v6 offset:46080
    s_waitcnt lgkmcnt(6)
    v_mfma_f32_32x32x16_bf16 v[64:79], v[48:51], a[8:11], v[64:79]
    ds_read_b64_tr_b16 v[40:41], v5 offset:32768
    ds_read_b64_tr_b16 v[42:43], v5 offset:33792
    s_waitcnt lgkmcnt(6)
    v_mfma_f32_32x32x16_bf16 v[80:95], v[52:55], a[8:11], v[80:95]
    ds_read_b64_tr_b16 v[44:45], v7 offset:32768
    ds_read_b64_tr_b16 v[46:47], v7 offset:33792
    s_waitcnt lgkmcnt(6)
    v_mfma_f32_32x32x16_bf16 v[64:79], v[32:35], a[12:15], v[64:79]
    ds_read_b64_tr_b16 v[48:49], v5 offset:36864
    ds_read_b64_tr_b16 v[50:51], v5 offset:37888
    s_waitcnt lgkmcnt(6)
    v_mfma_f32_32x32x16_bf16 v[80:95], v[36:39], a[12:15], v[80:95]
    ds_read_b64_tr_b16 v[52:53], v7 offset:36864
    ds_read_b64_tr_b16 v[54:55], v7 offset:37888
    s_waitcnt vmcnt(21)
    s_waitcnt lgkmcnt(6)
    v_mfma_f32_32x32x16_bf16 v[64:79], v[40:43], a[16:19], v[64:79]
    ds_read_b64_tr_b16 v[32:33], v5 offset:40960
    ds_read_b64_tr_b16 v[34:35], v5 offset:41984
    s_add_u32 s68, s3, 7
    s_and_b32 s68, s68, 7
    s_lshl_b32 s68, s68, 13
    s_add_u32 s75, s72, s68
    buffer_load_dwordx4 a[0:3], v1, s[52:55], s75 offen offset:0 sc1
    s_waitcnt lgkmcnt(6)
    v_mfma_f32_32x32x16_bf16 v[80:95], v[44:47], a[16:19], v[80:95]
    ds_read_b64_tr_b16 v[36:37], v7 offset:40960
    ds_read_b64_tr_b16 v[38:39], v7 offset:41984
    s_waitcnt lgkmcnt(6)
    v_mfma_f32_32x32x16_bf16 v[64:79], v[48:51], a[20:23], v[64:79]
    ds_read_b64_tr_b16 v[40:41], v5 offset:45056
    ds_read_b64_tr_b16 v[42:43], v5 offset:46080
    buffer_load_dwordx4 a[4:7], v1, s[52:55], s75 offen offset:2048 sc1
    s_waitcnt lgkmcnt(6)
    v_mfma_f32_32x32x16_bf16 v[80:95], v[52:55], a[20:23], v[80:95]
    ds_read_b64_tr_b16 v[44:45], v7 offset:45056
    ds_read_b64_tr_b16 v[46:47], v7 offset:46080
    s_waitcnt lgkmcnt(6)
    v_mfma_f32_32x32x16_bf16 v[64:79], v[32:35], a[24:27], v[64:79]
    ds_read_b64_tr_b16 v[48:49], v4 offset:49152
    ds_read_b64_tr_b16 v[50:51], v4 offset:50176
    s_add_u32 s75, s75, 4096
    buffer_load_dwordx4 a[8:11], v1, s[52:55], s75 offen offset:0 sc1
    s_waitcnt lgkmcnt(6)
    v_mfma_f32_32x32x16_bf16 v[80:95], v[36:39], a[24:27], v[80:95]
    ds_read_b64_tr_b16 v[52:53], v6 offset:49152
    ds_read_b64_tr_b16 v[54:55], v6 offset:50176
    s_waitcnt lgkmcnt(6)
    v_mfma_f32_32x32x16_bf16 v[64:79], v[40:43], a[28:31], v[64:79]
    ds_read_b64_tr_b16 v[32:33], v4 offset:53248
    ds_read_b64_tr_b16 v[34:35], v4 offset:54272
    buffer_load_dwordx4 a[12:15], v1, s[52:55], s75 offen offset:2048 sc1
    s_waitcnt lgkmcnt(6)
    v_mfma_f32_32x32x16_bf16 v[80:95], v[44:47], a[28:31], v[80:95]
    ds_read_b64_tr_b16 v[36:37], v6 offset:53248
    ds_read_b64_tr_b16 v[38:39], v6 offset:54272
    s_waitcnt vmcnt(21)
    s_waitcnt lgkmcnt(6)
    v_mfma_f32_32x32x16_bf16 v[64:79], v[48:51], a[32:35], v[64:79]
    ds_read_b64_tr_b16 v[40:41], v4 offset:57344
    ds_read_b64_tr_b16 v[42:43], v4 offset:58368
    s_waitcnt lgkmcnt(6)
    v_mfma_f32_32x32x16_bf16 v[80:95], v[52:55], a[32:35], v[80:95]
    ds_read_b64_tr_b16 v[44:45], v6 offset:57344
    ds_read_b64_tr_b16 v[46:47], v6 offset:58368
    s_waitcnt lgkmcnt(6)
    v_mfma_f32_32x32x16_bf16 v[64:79], v[32:35], a[36:39], v[64:79]
    ds_read_b64_tr_b16 v[48:49], v4 offset:61440
    ds_read_b64_tr_b16 v[50:51], v4 offset:62464
    s_waitcnt lgkmcnt(6)
    v_mfma_f32_32x32x16_bf16 v[80:95], v[36:39], a[36:39], v[80:95]
    ds_read_b64_tr_b16 v[52:53], v6 offset:61440
    ds_read_b64_tr_b16 v[54:55], v6 offset:62464
    v_mov_b32 v14, 13
    s_mov_b64 exec, 1
    ds_write_b32 v11, v14 offset:30736
    s_mov_b64 exec, -1
    s_waitcnt lgkmcnt(7)
    v_mfma_f32_32x32x16_bf16 v[64:79], v[40:43], a[40:43], v[64:79]
    ds_read_b64_tr_b16 v[32:33], v5 offset:49152
    ds_read_b64_tr_b16 v[34:35], v5 offset:50176
    s_waitcnt lgkmcnt(7)
    v_mfma_f32_32x32x16_bf16 v[80:95], v[44:47], a[40:43], v[80:95]
    ds_read_b64_tr_b16 v[36:37], v7 offset:49152
    ds_read_b64_tr_b16 v[38:39], v7 offset:50176
    s_waitcnt lgkmcnt(7)
    v_mfma_f32_32x32x16_bf16 v[64:79], v[48:51], a[44:47], v[64:79]
    ds_read_b64_tr_b16 v[40:41], v5 offset:53248
    ds_read_b64_tr_b16 v[42:43], v5 offset:54272
    s_waitcnt lgkmcnt(7)
    v_mfma_f32_32x32x16_bf16 v[80:95], v[52:55], a[44:47], v[80:95]
    ds_read_b64_tr_b16 v[44:45], v7 offset:53248
    ds_read_b64_tr_b16 v[46:47], v7 offset:54272
    ds_read_b64 v[12:13], v10 offset:30720
    s_waitcnt vmcnt(17)
    s_waitcnt lgkmcnt(7)
    v_mfma_f32_32x32x16_bf16 v[64:79], v[32:35], a[48:51], v[64:79]
    ds_read_b64_tr_b16 v[48:49], v5 offset:57344
    ds_read_b64_tr_b16 v[50:51], v5 offset:58368
    s_waitcnt lgkmcnt(7)
    v_mfma_f32_32x32x16_bf16 v[80:95], v[36:39], a[48:51], v[80:95]
    ds_read_b64_tr_b16 v[52:53], v7 offset:57344
    ds_read_b64_tr_b16 v[54:55], v7 offset:58368
    s_waitcnt lgkmcnt(7)
    v_mfma_f32_32x32x16_bf16 v[64:79], v[40:43], a[52:55], v[64:79]
    ds_read_b64_tr_b16 v[32:33], v5 offset:61440
    ds_read_b64_tr_b16 v[34:35], v5 offset:62464
    s_waitcnt lgkmcnt(7)
    v_mfma_f32_32x32x16_bf16 v[80:95], v[44:47], a[52:55], v[80:95]
    ds_read_b64_tr_b16 v[36:37], v7 offset:61440
    ds_read_b64_tr_b16 v[38:39], v7 offset:62464
    s_waitcnt lgkmcnt(8)
    v_min_u32 v12, v12, v13
    s_nop 0
    v_readfirstlane_b32 s65, v12
    s_cmp_ge_u32 s65, 12
    s_cbranch_scc0 L_spc_72
L_spd_73:
    s_waitcnt lgkmcnt(6)
    v_mfma_f32_32x32x16_bf16 v[64:79], v[48:51], a[56:59], v[64:79]
    ds_read_b64_tr_b16 v[40:41], v4 offset:0
    ds_read_b64_tr_b16 v[42:43], v4 offset:1024
    s_waitcnt lgkmcnt(6)
    v_mfma_f32_32x32x16_bf16 v[80:95], v[52:55], a[56:59], v[80:95]
    ds_read_b64_tr_b16 v[44:45], v6 offset:0
    ds_read_b64_tr_b16 v[46:47], v6 offset:1024
    s_waitcnt lgkmcnt(6)
    v_mfma_f32_32x32x16_bf16 v[64:79], v[32:35], a[60:63], v[64:79]
    ds_read_b64_tr_b16 v[48:49], v4 offset:4096
    ds_read_b64_tr_b16 v[50:51], v4 offset:5120
    s_waitcnt lgkmcnt(6)
    v_mfma_f32_32x32x16_bf16 v[80:95], v[36:39], a[60:63], v[80:95]
    ds_read_b64_tr_b16 v[52:53], v6 offset:4096
    ds_read_b64_tr_b16 v[54:55], v6 offset:5120
    s_waitcnt vmcnt(4)
    s_mov_b32 s64, 0
L_fs_74:
    v_cmp_eq_u32 vcc, s34, v2
    s_and_b32 s68, vcc_lo, 65280
    s_cmp_eq_u32 s68, 65280
    s_cbranch_scc1 L_fsd_75
    s_add_u32 s64, s64, 1
    s_cmp_gt_u32 s64, 100000
    s_cbranch_scc1 L_fsd_75
    s_sleep 2
    buffer_load_dword v2, v3, s[52:55], s74 offen sc1
    s_waitcnt vmcnt(0)
    s_branch L_fs_74
L_fsd_75:
    s_waitcnt lgkmcnt(6)
    v_mfma_f32_32x32x16_bf16 v[64:79], v[40:43], a[64:67], v[64:79]
    ds_read_b64_tr_b16 v[32:33], v4 offset:8192
    ds_read_b64_tr_b16 v[34:35], v4 offset:9216
    s_add_u32 s75, s72, 65536
    buffer_load_dwordx4 a[16:19], v1, s[52:55], s75 offen offset:0 sc1
    s_waitcnt lgkmcnt(6)
    v_mfma_f32_32x32x16_bf16 v[80:95], v[44:47], a[64:67], v[80:95]
    ds_read_b64_tr_b16 v[36:37], v6 offset:8192
    ds_read_b64_tr_b16 v[38:39], v6 offset:9216
    buffer_load_dwordx4 a[20:23], v1, s[52:55], s75 offen offset:2048 sc1
    s_waitcnt lgkmcnt(6)
    v_mfma_f32_32x32x16_bf16 v[64:79], v[48:51], a[68:71], v[64:79]
    ds_read_b64_tr_b16 v[40:41], v4 offset:12288
    ds_read_b64_tr_b16 v[42:43], v4 offset:13312
    s_add_u32 s75, s75, 4096
    buffer_load_dwordx4 a[24:27], v1, s[52:55], s75 offen offset:0 sc1
    s_waitcnt lgkmcnt(6)
    v_mfma_f32_32x32x16_bf16 v[80:95], v[52:55], a[68:71], v[80:95]
    ds_read_b64_tr_b16 v[44:45], v6 offset:12288
    ds_read_b64_tr_b16 v[46:47], v6 offset:13312
    buffer_load_dwordx4 a[28:31], v1, s[52:55], s75 offen offset:2048 sc1
    s_waitcnt lgkmcnt(6)
    v_mfma_f32_32x32x16_bf16 v[64:79], v[32:35], a[72:75], v[64:79]
    ds_read_b64_tr_b16 v[48:49], v5 offset:0
    ds_read_b64_tr_b16 v[50:51], v5 offset:1024
    s_add_u32 s75, s72, 73728
    buffer_load_dwordx4 a[32:35], v1, s[52:55], s75 offen offset:0 sc1
    s_waitcnt lgkmcnt(6)
    v_mfma_f32_32x32x16_bf16 v[80:95], v[36:39], a[72:75], v[80:95]
    ds_read_b64_tr_b16 v[52:53], v7 offset:0
    ds_read_b64_tr_b16 v[54:55], v7 offset:1024
    buffer_load_dwordx4 a[36:39], v1, s[52:55], s75 offen offset:2048 sc1
    s_waitcnt lgkmcnt(6)
    v_mfma_f32_32x32x16_bf16 v[64:79], v[40:43], a[76:79], v[64:79]
    ds_read_b64_tr_b16 v[32:33], v5 offset:4096
    ds_read_b64_tr_b16 v[34:35], v5 offset:5120
    s_add_u32 s75, s75, 4096
    buffer_load_dwordx4 a[40:43], v1, s[52:55], s75 offen offset:0 sc1
    s_waitcnt lgkmcnt(6)
    v_mfma_f32_32x32x16_bf16 v[80:95], v[44:47], a[76:79], v[80:95]
    ds_read_b64_tr_b16 v[36:37], v7 offset:4096
    ds_read_b64_tr_b16 v[38:39], v7 offset:5120
    ds_read_b64 v[12:13], v10 offset:30720
    s_waitcnt lgkmcnt(7)
    v_mfma_f32_32x32x16_bf16 v[64:79], v[48:51], a[80:83], v[64:79]
    ds_read_b64_tr_b16 v[40:41], v5 offset:8192
    ds_read_b64_tr_b16 v[42:43], v5 offset:9216
    buffer_load_dwordx4 a[44:47], v1, s[52:55], s75 offen offset:2048 sc1
    s_waitcnt lgkmcnt(7)
    v_mfma_f32_32x32x16_bf16 v[80:95], v[52:55], a[80:83], v[80:95]
    ds_read_b64_tr_b16 v[44:45], v7 offset:8192
    ds_read_b64_tr_b16 v[46:47], v7 offset:9216
    s_waitcnt lgkmcnt(7)
    v_mfma_f32_32x32x16_bf16 v[64:79], v[32:35], a[84:87], v[64:79]
    ds_read_b64_tr_b16 v[48:49], v5 offset:12288
    ds_read_b64_tr_b16 v[50:51], v5 offset:13312
    s_add_u32 s75, s72, 81920
    buffer_load_dwordx4 a[48:51], v1, s[52:55], s75 offen offset:0 sc1
    s_waitcnt lgkmcnt(7)
    v_mfma_f32_32x32x16_bf16 v[80:95], v[36:39], a[84:87], v[80:95]
    ds_read_b64_tr_b16 v[52:53], v7 offset:12288
    ds_read_b64_tr_b16 v[54:55], v7 offset:13312
    s_waitcnt lgkmcnt(8)
    v_min_u32 v12, v12, v13
    s_nop 0
    v_readfirstlane_b32 s65, v12
    s_cmp_ge_u32 s65, 13
    s_cbranch_scc0 L_spc_77
L_spd_78:
    s_waitcnt lgkmcnt(6)
    v_mfma_f32_32x32x16_bf16 v[64:79], v[40:43], a[88:91], v[64:79]
    ds_read_b64_tr_b16 v[32:33], v4 offset:16384
    ds_read_b64_tr_b16 v[34:35], v4 offset:17408
    buffer_load_dwordx4 a[52:55], v1, s[52:55], s75 offen offset:2048 sc1
    s_waitcnt lgkmcnt(6)
    v_mfma_f32_32x32x16_bf16 v[80:95], v[44:47], a[88:91], v[80:95]
    ds_read_b64_tr_b16 v[36:37], v6 offset:16384
    ds_read_b64_tr_b16 v[38:39], v6 offset:17408
    s_waitcnt lgkmcnt(6)
    v_mfma_f32_32x32x16_bf16 v[64:79], v[48:51], a[92:95], v[64:79]
    ds_read_b64_tr_b16 v[40:41], v4 offset:20480
    ds_read_b64_tr_b16 v[42:43], v4 offset:21504
    s_add_u32 s75, s75, 4096
    buffer_load_dwordx4 a[56:59], v1, s[52:55], s75 offen offset:0 sc1
    s_waitcnt lgkmcnt(6)
    v_mfma_f32_32x32x16_bf16 v[80:95], v[52:55], a[92:95], v[80:95]
    ds_read_b64_tr_b16 v[44:45], v6 offset:20480
    ds_read_b64_tr_b16 v[46:47], v6 offset:21504
    s_cmp_lg_u32 s28, 0
    s_cbranch_scc1 L_oc_79
    s_mov_b32 s64, 0
L_sp_80:
    ds_read_b32 v12, v10 offset:30764
    s_waitcnt lgkmcnt(0)
    v_readfirstlane_b32 s65, v12
    s_add_u32 s64, s64, 1
    s_cmp_ge_u32 s65, 2
    s_cbranch_scc1 L_spd_82
    s_cmp_lt_u32 s64, 400000
    s_cbranch_scc1 L_sp_80
L_spd_82:
    ds_read_b128 v[56:59], v28
    ds_read_b128 v[60:63], v29
    v_add_u32 v28, v28, v30
    v_add_u32 v29, v29, v30
    ds_read_b128 v[16:19], v28
    ds_read_b128 v[24:27], v29
    v_add_u32 v28, v28, v30
    v_add_u32 v29, v29, v30
    s_waitcnt lgkmcnt(2)
    v_mfma_f32_32x32x16_bf16 a[112:127], v[56:59], v[96:99], 0
    v_mfma_f32_32x32x16_bf16 a[112:127], v[60:63], v[100:103], a[112:127]
    ds_read_b128 v[56:59], v28
    ds_read_b128 v[60:63], v29
    v_add_u32 v28, v28, v30
    v_add_u32 v29, v29, v30
    s_nop 7
    v_accvgpr_read_b32 v12, a120
    v_accvgpr_read_b32 v96, a112
    v_accvgpr_read_b32 v97, a113
    v_accvgpr_read_b32 v98, a114
    v_accvgpr_read_b32 v99, a115
    v_accvgpr_read_b32 v100, a116
    v_accvgpr_read_b32 v101, a117
    v_accvgpr_read_b32 v102, a118
    v_accvgpr_read_b32 v103, a119
    v_add_f32 v12, 0x358637bd, v12
    v_rcp_f32 v12, v12
    s_nop 0
    v_pk_mul_f32 v[96:97], v[96:97], v[12:13] op_sel_hi:[1,0]
    v_pk_mul_f32 v[98:99], v[98:99], v[12:13] op_sel_hi:[1,0]
    v_pk_mul_f32 v[100:101], v[100:101], v[12:13] op_sel_hi:[1,0]
    v_pk_mul_f32 v[102:103], v[102:103], v[12:13] op_sel_hi:[1,0]
    v_cvt_pk_bf16_f32 v96, v96, v97
    v_cvt_pk_bf16_f32 v97, v98, v99
    v_cvt_pk_bf16_f32 v98, v100, v101
    v_cvt_pk_bf16_f32 v99, v102, v103
    s_cmp_eq_u32 s36, 0
    s_cbranch_scc1 L_wt_83
    buffer_store_dwordx4 v[96:99], v1, s[52:55], s73 offen offset:0
L_wtb_84:
    s_waitcnt lgkmcnt(2)
    v_mfma_f32_32x32x16_bf16 a[112:127], v[16:19], v[104:107], 0
    v_mfma_f32_32x32x16_bf16 a[112:127], v[24:27], v[108:111], a[112:127]
    ds_read_b128 v[16:19], v28
    ds_read_b128 v[24:27], v29
    s_nop 9
    v_accvgpr_read_b32 v12, a120
    v_accvgpr_read_b32 v104, a112
    v_accvgpr_read_b32 v105, a113
    v_accvgpr_read_b32 v106, a114
    v_accvgpr_read_b32 v107, a115
    v_accvgpr_read_b32 v108, a116
    v_accvgpr_read_b32 v109, a117
    v_accvgpr_read_b32 v110, a118
    v_accvgpr_read_b32 v111, a119
    v_add_f32 v12, 0x358637bd, v12
    v_rcp_f32 v12, v12
    s_nop 0
    v_pk_mul_f32 v[104:105], v[104:105], v[12:13] op_sel_hi:[1,0]
    v_pk_mul_f32 v[106:107], v[106:107], v[12:13] op_sel_hi:[1,0]
    v_pk_mul_f32 v[108:109], v[108:109], v[12:13] op_sel_hi:[1,0]
    v_pk_mul_f32 v[110:111], v[110:111], v[12:13] op_sel_hi:[1,0]
    v_cvt_pk_bf16_f32 v104, v104, v105
    v_cvt_pk_bf16_f32 v105, v106, v107
    v_cvt_pk_bf16_f32 v106, v108, v109
    v_cvt_pk_bf16_f32 v107, v110, v111
    s_cmp_eq_u32 s36, 0
    s_cbranch_scc1 L_wt_85
    buffer_store_dwordx4 v[104:107], v1, s[52:55], s73 offen offset:1024
L_wtb_86:
    s_waitcnt lgkmcnt(2)
    v_mfma_f32_32x32x16_bf16 a[112:127], v[56:59], v[112:115], 0
    v_mfma_f32_32x32x16_bf16 a[112:127], v[60:63], v[116:119], a[112:127]
    s_nop 11
    v_accvgpr_read_b32 v12, a120
    v_accvgpr_read_b32 v112, a112
    v_accvgpr_read_b32 v113, a113
    v_accvgpr_read_b32 v114, a114
    v_accvgpr_read_b32 v115, a115
    v_accvgpr_read_b32 v116, a116
    v_accvgpr_read_b32 v117, a117
    v_accvgpr_read_b32 v118, a118
    v_accvgpr_read_b32 v119, a119
    v_add_f32 v12, 0x358637bd, v12
    v_rcp_f32 v12, v12
    s_nop 0
    v_pk_mul_f32 v[112:113], v[112:113], v[12:13] op_sel_hi:[1,0]
    v_pk_mul_f32 v[114:115], v[114:115], v[12:13] op_sel_hi:[1,0]
    v_pk_mul_f32 v[116:117], v[116:117], v[12:13] op_sel_hi:[1,0]
    v_pk_mul_f32 v[118:119], v[118:119], v[12:13] op_sel_hi:[1,0]
    v_cvt_pk_bf16_f32 v112, v112, v113
    v_cvt_pk_bf16_f32 v113, v114, v115
    v_cvt_pk_bf16_f32 v114, v116, v117
    v_cvt_pk_bf16_f32 v115, v118, v119
    s_cmp_eq_u32 s36, 0
    s_cbranch_scc1 L_wt_87
    buffer_store_dwordx4 v[112:115], v1, s[52:55], s73 offen offset:2048
L_wtb_88:
    s_waitcnt lgkmcnt(0)
    v_mfma_f32_32x32x16_bf16 a[112:127], v[16:19], v[120:123], 0
    v_mfma_f32_32x32x16_bf16 a[112:127], v[24:27], v[124:127], a[112:127]
    s_nop 11
    v_accvgpr_read_b32 v12, a120
    v_accvgpr_read_b32 v120, a112
    v_accvgpr_read_b32 v121, a113
    v_accvgpr_read_b32 v122, a114
    v_accvgpr_read_b32 v123, a115
    v_accvgpr_read_b32 v124, a116
    v_accvgpr_read_b32 v125, a117
    v_accvgpr_read_b32 v126, a118
    v_accvgpr_read_b32 v127, a119
    v_add_f32 v12, 0x358637bd, v12
    v_rcp_f32 v12, v12
    s_nop 0
    v_pk_mul_f32 v[120:121], v[120:121], v[12:13] op_sel_hi:[1,0]
    v_pk_mul_f32 v[122:123], v[122:123], v[12:13] op_sel_hi:[1,0]
    v_pk_mul_f32 v[124:125], v[124:125], v[12:13] op_sel_hi:[1,0]
    v_pk_mul_f32 v[126:127], v[126:127], v[12:13] op_sel_hi:[1,0]
    v_cvt_pk_bf16_f32 v120, v120, v121
    v_cvt_pk_bf16_f32 v121, v122, v123
    v_cvt_pk_bf16_f32 v122, v124, v125
    v_cvt_pk_bf16_f32 v123, v126, v127
    s_cmp_eq_u32 s36, 0
    s_cbranch_scc1 L_wt_89
    buffer_store_dwordx4 v[120:123], v1, s[52:55], s73 offen offset:3072
L_wtb_90:
L_oc_79:
    s_waitcnt lgkmcnt(6)
    v_mfma_f32_32x32x16_bf16 v[64:79], v[32:35], a[96:99], v[64:79]
    ds_read_b64_tr_b16 v[48:49], v4 offset:24576
    ds_read_b64_tr_b16 v[50:51], v4 offset:25600
    s_waitcnt lgkmcnt(6)
    v_mfma_f32_32x32x16_bf16 v[80:95], v[36:39], a[96:99], v[80:95]
    ds_read_b64_tr_b16 v[52:53], v6 offset:24576
    ds_read_b64_tr_b16 v[54:55], v6 offset:25600
    s_waitcnt lgkmcnt(6)
    v_mfma_f32_32x32x16_bf16 v[64:79], v[40:43], a[100:103], v[64:79]
    ds_read_b64_tr_b16 v[32:33], v4 offset:28672
    ds_read_b64_tr_b16 v[34:35], v4 offset:29696
    s_waitcnt lgkmcnt(6)
    v_mfma_f32_32x32x16_bf16 v[80:95], v[44:47], a[100:103], v[80:95]
    ds_read_b64_tr_b16 v[36:37], v6 offset:28672
    ds_read_b64_tr_b16 v[38:39], v6 offset:29696
    v_mov_b32 v14, 14
    s_mov_b64 exec, 1
    ds_write_b32 v11, v14 offset:30736
    s_mov_b64 exec, -1
    s_waitcnt lgkmcnt(7)
    v_mfma_f32_32x32x16_bf16 v[64:79], v[48:51], a[104:107], v[64:79]
    ds_read_b64_tr_b16 v[40:41], v5 offset:16384
    ds_read_b64_tr_b16 v[42:43], v5 offset:17408
    s_waitcnt lgkmcnt(7)
    v_mfma_f32_32x32x16_bf16 v[80:95], v[52:55], a[104:107], v[80:95]
    ds_read_b64_tr_b16 v[44:45], v7 offset:16384
    ds_read_b64_tr_b16 v[46:47], v7 offset:17408
    s_waitcnt lgkmcnt(7)
    v_mfma_f32_32x32x16_bf16 v[64:79], v[32:35], a[108:111], v[64:79]
    ds_read_b64_tr_b16 v[48:49], v5 offset:20480
    ds_read_b64_tr_b16 v[50:51], v5 offset:21504
    s_waitcnt lgkmcnt(7)
    v_mfma_f32_32x32x16_bf16 v[80:95], v[36:39], a[108:111], v[80:95]
    ds_read_b64_tr_b16 v[52:53], v7 offset:20480
    ds_read_b64_tr_b16 v[54:55], v7 offset:21504
    s_cmp_lg_u32 s28, 0
    s_cbranch_scc1 L_of_91
    s_waitcnt vmcnt(0)
    s_lshl_b32 s68, s29, 2
    s_add_u32 s68, s68, s71
    s_add_u32 s68, s68, 64
    s_mov_b64 exec, 1
    s_cmp_eq_u32 s36, 0
    s_cbranch_scc1 L_wt_92
    buffer_store_dword v21, v20, s[52:55], s68 offen
L_wtb_93:
    s_mov_b64 exec, -1
L_of_91:
    ds_read_b64 v[12:13], v10 offset:30720
    s_waitcnt vmcnt(11)
    s_waitcnt lgkmcnt(7)
    v_mfma_f32_32x32x16_bf16 v[64:79], v[40:43], a[0:3], v[64:79]
    ds_read_b64_tr_b16 v[32:33], v5 offset:24576
    ds_read_b64_tr_b16 v[34:35], v5 offset:25600
    s_waitcnt lgkmcnt(7)
    v_mfma_f32_32x32x16_bf16 v[80:95], v[44:47], a[0:3], v[80:95]
    ds_read_b64_tr_b16 v[36:37], v7 offset:24576
    ds_read_b64_tr_b16 v[38:39], v7 offset:25600
    s_waitcnt lgkmcnt(7)
    v_mfma_f32_32x32x16_bf16 v[64:79], v[48:51], a[4:7], v[64:79]
    ds_read_b64_tr_b16 v[40:41], v5 offset:28672
    ds_read_b64_tr_b16 v[42:43], v5 offset:29696
    s_waitcnt lgkmcnt(7)
    v_mfma_f32_32x32x16_bf16 v[80:95], v[52:55], a[4:7], v[80:95]
    ds_read_b64_tr_b16 v[44:45], v7 offset:28672
    ds_read_b64_tr_b16 v[46:47], v7 offset:29696
    s_waitcnt lgkmcnt(8)
    v_min_u32 v12, v12, v13
    s_nop 0
    v_readfirstlane_b32 s65, v12
    s_cmp_ge_u32 s65, 14
    s_cbranch_scc0 L_spc_95
L_spd_96:
    s_waitcnt lgkmcnt(6)
    v_mfma_f32_32x32x16_bf16 v[64:79], v[32:35], a[8:11], v[64:79]
    ds_read_b64_tr_b16 v[48:49], v4 offset:32768
    ds_read_b64_tr_b16 v[50:51], v4 offset:33792
    s_waitcnt lgkmcnt(6)
    v_mfma_f32_32x32x16_bf16 v[80:95], v[36:39], a[8:11], v[80:95]
    ds_read_b64_tr_b16 v[52:53], v6 offset:32768
    ds_read_b64_tr_b16 v[54:55], v6 offset:33792
    s_waitcnt lgkmcnt(6)
    v_mfma_f32_32x32x16_bf16 v[64:79], v[40:43], a[12:15], v[64:79]
    ds_read_b64_tr_b16 v[32:33], v4 offset:36864
    ds_read_b64_tr_b16 v[34:35], v4 offset:37888
    s_waitcnt lgkmcnt(6)
    v_mfma_f32_32x32x16_bf16 v[80:95], v[44:47], a[12:15], v[80:95]
    ds_read_b64_tr_b16 v[36:37], v6 offset:36864
    ds_read_b64_tr_b16 v[38:39], v6 offset:37888
    ds_read_b64 v[120:121], v8 offset:0
    ds_read_b64 v[122:123], v8 offset:16
    ds_read_b64 v[124:125], v8 offset:32
    ds_read_b64 v[126:127], v8 offset:48
    buffer_load_dword v2, v3, s[52:55], s74 offen sc1
    s_waitcnt vmcnt(8)
    s_waitcnt lgkmcnt(10)
    v_mfma_f32_32x32x16_bf16 v[64:79], v[48:51], a[16:19], v[64:79]
    ds_read_b64_tr_b16 v[40:41], v4 offset:40960
    ds_read_b64_tr_b16 v[42:43], v4 offset:41984
    s_waitcnt lgkmcnt(10)
    v_mfma_f32_32x32x16_bf16 v[80:95], v[52:55], a[16:19], v[80:95]
    ds_read_b64_tr_b16 v[44:45], v6 offset:40960
    ds_read_b64_tr_b16 v[46:47], v6 offset:41984
    s_waitcnt lgkmcnt(10)
    v_mfma_f32_32x32x16_bf16 v[64:79], v[32:35], a[20:23], v[64:79]
    ds_read_b64_tr_b16 v[48:49], v4 offset:45056
    ds_read_b64_tr_b16 v[50:51], v4 offset:46080
    s_waitcnt lgkmcnt(10)
    v_mfma_f32_32x32x16_bf16 v[80:95], v[36:39], a[20:23], v[80:95]
    ds_read_b64_tr_b16 v[52:53], v6 offset:45056
    ds_read_b64_tr_b16 v[54:55], v6 offset:46080
    s_waitcnt lgkmcnt(6)
    v_mfma_f32_32x32x16_bf16 v[64:79], v[40:43], a[24:27], v[64:79]
    ds_read_b64_tr_b16 v[32:33], v5 offset:32768
    ds_read_b64_tr_b16 v[34:35], v5 offset:33792
    s_waitcnt lgkmcnt(6)
    v_mfma_f32_32x32x16_bf16 v[80:95], v[44:47], a[24:27], v[80:95]
    ds_read_b64_tr_b16 v[36:37], v7 offset:32768
    ds_read_b64_tr_b16 v[38:39], v7 offset:33792
    s_waitcnt lgkmcnt(6)
    v_mfma_f32_32x32x16_bf16 v[64:79], v[48:51], a[28:31], v[64:79]
    ds_read_b64_tr_b16 v[40:41], v5 offset:36864
    ds_read_b64_tr_b16 v[42:43], v5 offset:37888
    s_waitcnt lgkmcnt(6)
    v_mfma_f32_32x32x16_bf16 v[80:95], v[52:55], a[28:31], v[80:95]
    ds_read_b64_tr_b16 v[44:45], v7 offset:36864
    ds_read_b64_tr_b16 v[46:47], v7 offset:37888
    ds_read_b64 v[112:113], v15 offset:0
    ds_read_b64 v[114:115], v15 offset:16
    ds_read_b64 v[116:117], v15 offset:32
    ds_read_b64 v[118:119], v15 offset:48
    s_waitcnt vmcnt(0)
    s_mov_b32 s64, 0
L_fs_97:
    v_cmp_eq_u32 vcc, s34, v2
    s_and_b32 s68, vcc_lo, 16711680
    s_cmp_eq_u32 s68, 16711680
    s_cbranch_scc1 L_fsd_98
    s_add_u32 s64, s64, 1
    s_cmp_gt_u32 s64, 100000
    s_cbranch_scc1 L_fsd_98
    s_sleep 2
    buffer_load_dword v2, v3, s[52:55], s74 offen sc1
    s_waitcnt vmcnt(0)
    s_branch L_fs_97
L_fsd_98:
    s_lshl_b32 s68, s2, 2
    s_add_u32 s68, s68, s33
    s_cmp_lg_u32 s68, 0
    s_cbranch_scc1 L_bump_99
    s_mov_b32 s68, 16384
    s_mov_b64 exec, 1
    buffer_store_dword v21, v20, s[52:55], s68 offen sc1
    s_mov_b64 exec, -1
L_bump_99:
    s_waitcnt lgkmcnt(10)
    v_mfma_f32_32x32x16_bf16 v[64:79], v[32:35], a[32:35], v[64:79]
    ds_read_b64_tr_b16 v[48:49], v5 offset:40960
    ds_read_b64_tr_b16 v[50:51], v5 offset:41984
    s_lshr_b32 s68, s3, 1
    s_add_u32 s68, s68, 0
    s_and_b32 s68, s68, 3
    s_lshl_b32 s68, s68, 13
    s_add_u32 s75, s72, s68
    s_add_u32 s75, s75, 90112
    buffer_load_dwordx4 a[64:67], v1, s[52:55], s75 offen offset:0 sc1
    s_waitcnt lgkmcnt(10)
    v_mfma_f32_32x32x16_bf16 v[80:95], v[36:39], a[32:35], v[80:95]
    ds_read_b64_tr_b16 v[52:53], v7 offset:40960
    ds_read_b64_tr_b16 v[54:55], v7 offset:41984
    buffer_load_dwordx4 a[68:71], v1, s[52:55], s75 offen offset:2048 sc1
    s_waitcnt lgkmcnt(10)
    v_mfma_f32_32x32x16_bf16 v[64:79], v[40:43], a[36:39], v[64:79]
    ds_read_b64_tr_b16 v[32:33], v5 offset:45056
    ds_read_b64_tr_b16 v[34:35], v5 offset:46080
    s_add_u32 s75, s75, 4096
    buffer_load_dwordx4 a[72:75], v1, s[52:55], s75 offen offset:0 sc1
    s_waitcnt lgkmcnt(10)
    v_mfma_f32_32x32x16_bf16 v[80:95], v[44:47], a[36:39], v[80:95]
    ds_read_b64_tr_b16 v[36:37], v7 offset:45056
    ds_read_b64_tr_b16 v[38:39], v7 offset:46080
    buffer_load_dwordx4 a[76:79], v1, s[52:55], s75 offen offset:2048 sc1
    s_waitcnt lgkmcnt(6)
    v_mfma_f32_32x32x16_bf16 v[64:79], v[48:51], a[40:43], v[64:79]
    ds_read_b64_tr_b16 v[40:41], v4 offset:49152
    ds_read_b64_tr_b16 v[42:43], v4 offset:50176
    s_lshr_b32 s68, s3, 1
    s_add_u32 s68, s68, 1
    s_and_b32 s68, s68, 3
    s_lshl_b32 s68, s68, 13
    s_add_u32 s75, s72, s68
    s_add_u32 s75, s75, 90112
    buffer_load_dwordx4 a[80:83], v1, s[52:55], s75 offen offset:0 sc1
    s_waitcnt lgkmcnt(6)
    v_mfma_f32_32x32x16_bf16 v[80:95], v[52:55], a[40:43], v[80:95]
    ds_read_b64_tr_b16 v[44:45], v6 offset:49152
    ds_read_b64_tr_b16 v[46:47], v6 offset:50176
    buffer_load_dwordx4 a[84:87], v1, s[52:55], s75 offen offset:2048 sc1
    ds_read_b64 v[12:13], v10 offset:30720
    s_waitcnt lgkmcnt(7)
    v_mfma_f32_32x32x16_bf16 v[64:79], v[32:35], a[44:47], v[64:79]
    ds_read_b64_tr_b16 v[48:49], v4 offset:53248
    ds_read_b64_tr_b16 v[50:51], v4 offset:54272
    s_add_u32 s75, s75, 4096
    buffer_load_dwordx4 a[88:91], v1, s[52:55], s75 offen offset:0 sc1
    s_waitcnt lgkmcnt(7)
    v_mfma_f32_32x32x16_bf16 v[80:95], v[36:39], a[44:47], v[80:95]
    ds_read_b64_tr_b16 v[52:53], v6 offset:53248
    ds_read_b64_tr_b16 v[54:55], v6 offset:54272
    buffer_load_dwordx4 a[92:95], v1, s[52:55], s75 offen offset:2048 sc1
    v_lshlrev_b32 v24, 16, v120
    v_and_b32 v25, 0xffff0000, v120
    v_lshlrev_b32 v26, 16, v112
    v_and_b32 v27, 0xffff0000, v112
    v_pk_add_f32 v[96:97], v[24:25], v[26:27]
    v_lshlrev_b32 v24, 16, v121
    v_and_b32 v25, 0xffff0000, v121
    v_lshlrev_b32 v26, 16, v113
    v_and_b32 v27, 0xffff0000, v113
    v_pk_add_f32 v[98:99], v[24:25], v[26:27]
    v_lshlrev_b32 v24, 16, v122
    v_and_b32 v25, 0xffff0000, v122
    v_lshlrev_b32 v26, 16, v114
    v_and_b32 v27, 0xffff0000, v114
    v_pk_add_f32 v[100:101], v[24:25], v[26:27]
    v_lshlrev_b32 v24, 16, v123
    v_and_b32 v25, 0xffff0000, v123
    v_lshlrev_b32 v26, 16, v115
    v_and_b32 v27, 0xffff0000, v115
    v_pk_add_f32 v[102:103], v[24:25], v[26:27]
    v_lshlrev_b32 v24, 16, v124
    v_and_b32 v25, 0xffff0000, v124
    v_lshlrev_b32 v26, 16, v116
    v_and_b32 v27, 0xffff0000, v116
    v_pk_add_f32 v[104:105], v[24:25], v[26:27]
    v_lshlrev_b32 v24, 16, v125
    v_and_b32 v25, 0xffff0000, v125
    v_lshlrev_b32 v26, 16, v117
    v_and_b32 v27, 0xffff0000, v117
    v_pk_add_f32 v[106:107], v[24:25], v[26:27]
    v_lshlrev_b32 v24, 16, v126
    v_and_b32 v25, 0xffff0000, v126
    v_lshlrev_b32 v26, 16, v118
    v_and_b32 v27, 0xffff0000, v118
    v_pk_add_f32 v[108:109], v[24:25], v[26:27]
    v_lshlrev_b32 v24, 16, v127
    v_and_b32 v25, 0xffff0000, v127
    v_lshlrev_b32 v26, 16, v119
    v_and_b32 v27, 0xffff0000, v119
    v_pk_add_f32 v[110:111], v[24:25], v[26:27]
    s_waitcnt lgkmcnt(7)
    v_mfma_f32_32x32x16_bf16 v[64:79], v[40:43], a[48:51], v[64:79]
    ds_read_b64_tr_b16 v[32:33], v4 offset:57344
    ds_read_b64_tr_b16 v[34:35], v4 offset:58368
    s_lshr_b32 s68, s3, 1
    s_add_u32 s68, s68, 2
    s_and_b32 s68, s68, 3
    s_lshl_b32 s68, s68, 13
    s_add_u32 s75, s72, s68
    s_add_u32 s75, s75, 90112
    buffer_load_dwordx4 a[96:99], v1, s[52:55], s75 offen offset:0 sc1
    s_waitcnt lgkmcnt(7)
    v_mfma_f32_32x32x16_bf16 v[80:95], v[44:47], a[48:51], v[80:95]
    ds_read_b64_tr_b16 v[36:37], v6 offset:57344
    ds_read_b64_tr_b16 v[38:39], v6 offset:58368
    buffer_load_dwordx4 a[100:103], v1, s[52:55], s75 offen offset:2048 sc1
    s_waitcnt lgkmcnt(8)
    v_min_u32 v12, v12, v13
    s_nop 0
    v_readfirstlane_b32 s65, v12
    s_cmp_ge_u32 s65, 15
    s_cbranch_scc0 L_spc_101
L_spd_102:
    s_waitcnt lgkmcnt(6)
    v_mfma_f32_32x32x16_bf16 v[64:79], v[48:51], a[52:55], v[64:79]
    ds_read_b64_tr_b16 v[40:41], v5 offset:49152
    ds_read_b64_tr_b16 v[42:43], v5 offset:50176
    s_add_u32 s75, s75, 4096
    buffer_load_dwordx4 a[104:107], v1, s[52:55], s75 offen offset:0 sc1
    s_waitcnt lgkmcnt(6)
    v_mfma_f32_32x32x16_bf16 v[80:95], v[52:55], a[52:55], v[80:95]
    ds_read_b64_tr_b16 v[44:45], v7 offset:49152
    ds_read_b64_tr_b16 v[46:47], v7 offset:50176
    buffer_load_dwordx4 a[108:111], v1, s[52:55], s75 offen offset:2048 sc1
    s_waitcnt lgkmcnt(6)
    v_mfma_f32_32x32x16_bf16 v[64:79], v[32:35], a[56:59], v[64:79]
    ds_read_b64_tr_b16 v[48:49], v5 offset:53248
    ds_read_b64_tr_b16 v[50:51], v5 offset:54272
    s_lshr_b32 s68, s3, 1
    s_add_u32 s68, s68, 3
    s_and_b32 s68, s68, 3
    s_lshl_b32 s68, s68, 13
    s_add_u32 s75, s72, s68
    s_add_u32 s75, s75, 90112
    buffer_load_dwordx4 a[0:3], v1, s[52:55], s75 offen offset:0 sc1
    s_waitcnt lgkmcnt(6)
    v_mfma_f32_32x32x16_bf16 v[80:95], v[36:39], a[56:59], v[80:95]
    ds_read_b64_tr_b16 v[52:53], v7 offset:53248
    ds_read_b64_tr_b16 v[54:55], v7 offset:54272
    s_waitcnt vmcnt(9)
    s_waitcnt lgkmcnt(6)
    v_mfma_f32_32x32x16_bf16 v[64:79], v[40:43], a[64:67], v[64:79]
    ds_read_b64_tr_b16 v[32:33], v5 offset:57344
    ds_read_b64_tr_b16 v[34:35], v5 offset:58368
    buffer_load_dwordx4 a[4:7], v1, s[52:55], s75 offen offset:2048 sc1
    s_waitcnt lgkmcnt(6)
    v_mfma_f32_32x32x16_bf16 v[80:95], v[44:47], a[64:67], v[80:95]
    ds_read_b64_tr_b16 v[36:37], v7 offset:57344
    ds_read_b64_tr_b16 v[38:39], v7 offset:58368
    s_waitcnt lgkmcnt(6)
    v_mfma_f32_32x32x16_bf16 v[64:79], v[48:51], a[68:71], v[64:79]
    ds_read_b64_tr_b16 v[40:41], v5 offset:61440
    ds_read_b64_tr_b16 v[42:43], v5 offset:62464
    s_add_u32 s75, s75, 4096
    buffer_load_dwordx4 a[8:11], v1, s[52:55], s75 offen offset:0 sc1
    s_waitcnt lgkmcnt(6)
    v_mfma_f32_32x32x16_bf16 v[80:95], v[52:55], a[68:71], v[80:95]
    ds_read_b64_tr_b16 v[44:45], v7 offset:61440
    ds_read_b64_tr_b16 v[46:47], v7 offset:62464
    s_waitcnt lgkmcnt(6)
    v_mfma_f32_32x32x16_bf16 v[64:79], v[32:35], a[72:75], v[64:79]
    ds_read_b64_tr_b16 v[48:49], v4 offset:0
    ds_read_b64_tr_b16 v[50:51], v4 offset:1024
    buffer_load_dwordx4 a[12:15], v1, s[52:55], s75 offen offset:2048 sc1
    s_waitcnt lgkmcnt(6)
    v_mfma_f32_32x32x16_bf16 v[80:95], v[36:39], a[72:75], v[80:95]
    ds_read_b64_tr_b16 v[52:53], v6 offset:0
    ds_read_b64_tr_b16 v[54:55], v6 offset:1024
    s_waitcnt lgkmcnt(6)
    v_mfma_f32_32x32x16_bf16 v[64:79], v[40:43], a[76:79], v[64:79]
    ds_read_b64_tr_b16 v[32:33], v4 offset:4096
    ds_read_b64_tr_b16 v[34:35], v4 offset:5120
    s_waitcnt lgkmcnt(6)
    v_mfma_f32_32x32x16_bf16 v[80:95], v[44:47], a[76:79], v[80:95]
    ds_read_b64_tr_b16 v[36:37], v6 offset:4096
    ds_read_b64_tr_b16 v[38:39], v6 offset:5120
    s_waitcnt vmcnt(8)
    s_waitcnt lgkmcnt(6)
    v_mfma_f32_32x32x16_bf16 v[64:79], v[48:51], a[80:83], v[64:79]
    ds_read_b64_tr_b16 v[40:41], v4 offset:8192
    ds_read_b64_tr_b16 v[42:43], v4 offset:9216
    s_waitcnt lgkmcnt(6)
    v_mfma_f32_32x32x16_bf16 v[80:95], v[52:55], a[80:83], v[80:95]
    ds_read_b64_tr_b16 v[44:45], v6 offset:8192
    ds_read_b64_tr_b16 v[46:47], v6 offset:9216
    s_waitcnt lgkmcnt(6)
    v_mfma_f32_32x32x16_bf16 v[64:79], v[32:35], a[84:87], v[64:79]
    ds_read_b64_tr_b16 v[48:49], v4 offset:12288
    ds_read_b64_tr_b16 v[50:51], v4 offset:13312
    s_waitcnt lgkmcnt(6)
    v_mfma_f32_32x32x16_bf16 v[80:95], v[36:39], a[84:87], v[80:95]
    ds_read_b64_tr_b16 v[52:53], v6 offset:12288
    ds_read_b64_tr_b16 v[54:55], v6 offset:13312
    s_waitcnt lgkmcnt(6)
    v_mfma_f32_32x32x16_bf16 v[64:79], v[40:43], a[88:91], v[64:79]
    ds_read_b64_tr_b16 v[32:33], v5 offset:0
    ds_read_b64_tr_b16 v[34:35], v5 offset:1024
    s_waitcnt lgkmcnt(6)
    v_mfma_f32_32x32x16_bf16 v[80:95], v[44:47], a[88:91], v[80:95]
    ds_read_b64_tr_b16 v[36:37], v7 offset:0
    ds_read_b64_tr_b16 v[38:39], v7 offset:1024
    s_waitcnt lgkmcnt(6)
    v_mfma_f32_32x32x16_bf16 v[64:79], v[48:51], a[92:95], v[64:79]
    ds_read_b64_tr_b16 v[40:41], v5 offset:4096
    ds_read_b64_tr_b16 v[42:43], v5 offset:5120
    s_waitcnt lgkmcnt(6)
    v_mfma_f32_32x32x16_bf16 v[80:95], v[52:55], a[92:95], v[80:95]
    ds_read_b64_tr_b16 v[44:45], v7 offset:4096
    ds_read_b64_tr_b16 v[46:47], v7 offset:5120
    s_waitcnt vmcnt(4)
    s_waitcnt lgkmcnt(6)
    v_mfma_f32_32x32x16_bf16 v[64:79], v[32:35], a[96:99], v[64:79]
    ds_read_b64_tr_b16 v[48:49], v5 offset:8192
    ds_read_b64_tr_b16 v[50:51], v5 offset:9216
    s_waitcnt lgkmcnt(6)
    v_mfma_f32_32x32x16_bf16 v[80:95], v[36:39], a[96:99], v[80:95]
    ds_read_b64_tr_b16 v[52:53], v7 offset:8192
    ds_read_b64_tr_b16 v[54:55], v7 offset:9216
    s_waitcnt lgkmcnt(6)
    v_mfma_f32_32x32x16_bf16 v[64:79], v[40:43], a[100:103], v[64:79]
    ds_read_b64_tr_b16 v[32:33], v5 offset:12288
    ds_read_b64_tr_b16 v[34:35], v5 offset:13312
    s_waitcnt lgkmcnt(6)
    v_mfma_f32_32x32x16_bf16 v[80:95], v[44:47], a[100:103], v[80:95]
    ds_read_b64_tr_b16 v[36:37], v7 offset:12288
    ds_read_b64_tr_b16 v[38:39], v7 offset:13312
    s_waitcnt lgkmcnt(6)
    v_mfma_f32_32x32x16_bf16 v[64:79], v[48:51], a[104:107], v[64:79]
    ds_read_b64_tr_b16 v[40:41], v4 offset:16384
    ds_read_b64_tr_b16 v[42:43], v4 offset:17408
    s_waitcnt lgkmcnt(6)
    v_mfma_f32_32x32x16_bf16 v[80:95], v[52:55], a[104:107], v[80:95]
    ds_read_b64_tr_b16 v[44:45], v6 offset:16384
    ds_read_b64_tr_b16 v[46:47], v6 offset:17408
    s_waitcnt lgkmcnt(6)
    v_mfma_f32_32x32x16_bf16 v[64:79], v[32:35], a[108:111], v[64:79]
    ds_read_b64_tr_b16 v[48:49], v4 offset:20480
    ds_read_b64_tr_b16 v[50:51], v4 offset:21504
    s_waitcnt lgkmcnt(6)
    v_mfma_f32_32x32x16_bf16 v[80:95], v[36:39], a[108:111], v[80:95]
    ds_read_b64_tr_b16 v[52:53], v6 offset:20480
    ds_read_b64_tr_b16 v[54:55], v6 offset:21504
    s_waitcnt vmcnt(0)
    s_waitcnt lgkmcnt(6)
    v_mfma_f32_32x32x16_bf16 v[64:79], v[40:43], a[0:3], v[64:79]
    ds_read_b64_tr_b16 v[32:33], v4 offset:24576
    ds_read_b64_tr_b16 v[34:35], v4 offset:25600
    s_waitcnt lgkmcnt(6)
    v_mfma_f32_32x32x16_bf16 v[80:95], v[44:47], a[0:3], v[80:95]
    ds_read_b64_tr_b16 v[36:37], v6 offset:24576
    ds_read_b64_tr_b16 v[38:39], v6 offset:25600
    s_waitcnt lgkmcnt(6)
    v_mfma_f32_32x32x16_bf16 v[64:79], v[48:51], a[4:7], v[64:79]
    ds_read_b64_tr_b16 v[40:41], v4 offset:28672
    ds_read_b64_tr_b16 v[42:43], v4 offset:29696
    s_waitcnt lgkmcnt(6)
    v_mfma_f32_32x32x16_bf16 v[80:95], v[52:55], a[4:7], v[80:95]
    ds_read_b64_tr_b16 v[44:45], v6 offset:28672
    ds_read_b64_tr_b16 v[46:47], v6 offset:29696
    s_waitcnt lgkmcnt(6)
    v_mfma_f32_32x32x16_bf16 v[64:79], v[32:35], a[8:11], v[64:79]
    s_waitcnt lgkmcnt(4)
    v_mfma_f32_32x32x16_bf16 v[80:95], v[36:39], a[8:11], v[80:95]
    s_waitcnt lgkmcnt(2)
    v_mfma_f32_32x32x16_bf16 v[64:79], v[40:43], a[12:15], v[64:79]
    s_waitcnt lgkmcnt(0)
    v_mfma_f32_32x32x16_bf16 v[80:95], v[44:47], a[12:15], v[80:95]
    s_lshl_b32 s68, s33, 12
    v_add_u32 v12, s68, v23
    s_xor_b32 s68, s68, 0x1000
    v_add_u32 v13, s68, v23
    s_and_b32 s68, s33, 1
    s_cmp_eq_u32 s68, 0
    s_nop 6
    s_cbranch_scc1 L_kh_103
    ds_write_b128 v12, v[64:67] offset:0
    ds_write_b128 v12, v[68:71] offset:1024
    ds_write_b128 v12, v[72:75] offset:2048
    ds_write_b128 v12, v[76:79] offset:3072
    v_pk_add_f32 v[96:97], v[96:97], v[80:81]
    v_pk_add_f32 v[98:99], v[98:99], v[82:83]
    v_pk_add_f32 v[100:101], v[100:101], v[84:85]
    v_pk_add_f32 v[102:103], v[102:103], v[86:87]
    v_pk_add_f32 v[104:105], v[104:105], v[88:89]
    v_pk_add_f32 v[106:107], v[106:107], v[90:91]
    v_pk_add_f32 v[108:109], v[108:109], v[92:93]
    v_pk_add_f32 v[110:111], v[110:111], v[94:95]
    s_branch L_kh2_104
L_kh_103:
    ds_write_b128 v12, v[80:83] offset:0
    ds_write_b128 v12, v[84:87] offset:1024
    ds_write_b128 v12, v[88:91] offset:2048
    ds_write_b128 v12, v[92:95] offset:3072
    v_pk_add_f32 v[96:97], v[96:97], v[64:65]
    v_pk_add_f32 v[98:99], v[98:99], v[66:67]
    v_pk_add_f32 v[100:101], v[100:101], v[68:69]
    v_pk_add_f32 v[102:103], v[102:103], v[70:71]
    v_pk_add_f32 v[104:105], v[104:105], v[72:73]
    v_pk_add_f32 v[106:107], v[106:107], v[74:75]
    v_pk_add_f32 v[108:109], v[108:109], v[76:77]
    v_pk_add_f32 v[110:111], v[110:111], v[78:79]
L_kh2_104:
    s_waitcnt lgkmcnt(0)
    s_barrier
    ds_read_b128 v[32:35], v13 offset:0
    ds_read_b128 v[36:39], v13 offset:1024
    ds_read_b128 v[40:43], v13 offset:2048
    ds_read_b128 v[44:47], v13 offset:3072
    s_waitcnt lgkmcnt(3)
    v_pk_add_f32 v[96:97], v[96:97], v[32:33]
    v_pk_add_f32 v[98:99], v[98:99], v[34:35]
    s_waitcnt lgkmcnt(2)
    v_pk_add_f32 v[100:101], v[100:101], v[36:37]
    v_pk_add_f32 v[102:103], v[102:103], v[38:39]
    s_waitcnt lgkmcnt(1)
    v_pk_add_f32 v[104:105], v[104:105], v[40:41]
    v_pk_add_f32 v[106:107], v[106:107], v[42:43]
    s_waitcnt lgkmcnt(0)
    v_pk_add_f32 v[108:109], v[108:109], v[44:45]
    v_pk_add_f32 v[110:111], v[110:111], v[46:47]
    v_cvt_pk_bf16_f32 v96, v96, v97
    v_cvt_pk_bf16_f32 v97, v98, v99
    v_cvt_pk_bf16_f32 v98, v100, v101
    v_cvt_pk_bf16_f32 v99, v102, v103
    v_cvt_pk_bf16_f32 v100, v104, v105
    v_cvt_pk_bf16_f32 v101, v106, v107
    v_cvt_pk_bf16_f32 v102, v108, v109
    v_cvt_pk_bf16_f32 v103, v110, v111
    s_nop 1
    v_permlane32_swap_b32 v96, v98
    v_permlane32_swap_b32 v97, v99
    v_permlane32_swap_b32 v100, v102
    v_permlane32_swap_b32 v101, v103
    buffer_store_dwordx4 v[96:99], v9, s[56:59], s66 offen
    buffer_store_dwordx4 v[100:103], v9, s[56:59], s66 offen offset:32
    s_endpgm
L_spc_42:
    s_mov_b32 s64, 0
L_sp_41:
    ds_read_b32 v24, v10 offset:30752
    s_waitcnt lgkmcnt(0)
    v_readfirstlane_b32 s65, v24
    s_add_u32 s64, s64, 1
    s_cmp_ge_u32 s65, 2
    s_cbranch_scc1 L_spd_43
    s_cmp_lt_u32 s64, 400000
    s_cbranch_scc1 L_sp_41
    s_branch L_spd_43
L_wt_44:
    buffer_store_dwordx4 v[96:99], v1, s[52:55], s68 offen sc1
    buffer_store_dwordx4 v[100:103], v1, s[52:55], s68 offen offset:1024 sc1
    s_branch L_wtb_45
L_wt_46:
    buffer_store_dwordx4 v[112:115], v1, s[52:55], s68 offen sc1
    buffer_store_dwordx4 v[116:119], v1, s[52:55], s68 offen offset:1024 sc1
    s_branch L_wtb_47
L_wt_48:
    buffer_store_dwordx4 v[64:67], v1, s[52:55], s68 offen sc1
    buffer_store_dwordx4 v[68:71], v1, s[52:55], s68 offen offset:1024 sc1
    s_branch L_wtb_49
L_wt_50:
    buffer_store_dwordx4 v[80:83], v1, s[52:55], s68 offen sc1
    buffer_store_dwordx4 v[84:87], v1, s[52:55], s68 offen offset:1024 sc1
    s_branch L_wtb_51
L_wt_56:
    buffer_store_dword v21, v20, s[52:55], s68 offen sc1
    s_branch L_wtb_57
L_wt_58:
    buffer_store_dwordx4 v[64:67], v1, s[52:55], s69 offen sc1
    buffer_store_dwordx4 v[68:71], v1, s[52:55], s69 offen offset:1024 sc1
    s_branch L_wtb_59
L_wt_61:
    buffer_store_dwordx4 v[80:83], v1, s[52:55], s69 offen sc1
    buffer_store_dwordx4 v[84:87], v1, s[52:55], s69 offen offset:1024 sc1
    s_branch L_wtb_62
L_wt_66:
    buffer_store_dword v21, v20, s[52:55], s68 offen sc1
    s_branch L_wtb_67
L_spc_72:
    s_mov_b32 s64, 0
L_sp_71:
    ds_read_b64 v[12:13], v10 offset:30720
    s_waitcnt lgkmcnt(0)
    v_min_u32 v12, v12, v13
    s_nop 0
    v_readfirstlane_b32 s65, v12
    s_add_u32 s64, s64, 1
    s_cmp_ge_u32 s65, 12
    s_cbranch_scc1 L_spd_73
    s_cmp_lt_u32 s64, 400000
    s_cbranch_scc1 L_sp_71
    s_branch L_spd_73
L_spc_77:
    s_mov_b32 s64, 0
L_sp_76:
    ds_read_b64 v[12:13], v10 offset:30720
    s_waitcnt lgkmcnt(0)
    v_min_u32 v12, v12, v13
    s_nop 0
    v_readfirstlane_b32 s65, v12
    s_add_u32 s64, s64, 1
    s_cmp_ge_u32 s65, 13
    s_cbranch_scc1 L_spd_78
    s_cmp_lt_u32 s64, 400000
    s_cbranch_scc1 L_sp_76
    s_branch L_spd_78
L_wt_83:
    buffer_store_dwordx4 v[96:99], v1, s[52:55], s73 offen offset:0 sc1
    s_branch L_wtb_84
L_wt_85:
    buffer_store_dwordx4 v[104:107], v1, s[52:55], s73 offen offset:1024 sc1
    s_branch L_wtb_86
L_wt_87:
    buffer_store_dwordx4 v[112:115], v1, s[52:55], s73 offen offset:2048 sc1
    s_branch L_wtb_88
L_wt_89:
    buffer_store_dwordx4 v[120:123], v1, s[52:55], s73 offen offset:3072 sc1
    s_branch L_wtb_90
L_wt_92:
    buffer_store_dword v21, v20, s[52:55], s68 offen sc1
    s_branch L_wtb_93
L_spc_95:
    s_mov_b32 s64, 0
L_sp_94:
    ds_read_b64 v[12:13], v10 offset:30720
    s_waitcnt lgkmcnt(0)
    v_min_u32 v12, v12, v13
    s_nop 0
    v_readfirstlane_b32 s65, v12
    s_add_u32 s64, s64, 1
    s_cmp_ge_u32 s65, 14
    s_cbranch_scc1 L_spd_96
    s_cmp_lt_u32 s64, 400000
    s_cbranch_scc1 L_sp_94
    s_branch L_spd_96
L_spc_101:
    s_mov_b32 s64, 0
L_sp_100:
    ds_read_b64 v[12:13], v10 offset:30720
    s_waitcnt lgkmcnt(0)
    v_min_u32 v12, v12, v13
    s_nop 0
    v_readfirstlane_b32 s65, v12
    s_add_u32 s64, s64, 1
    s_cmp_ge_u32 s65, 15
    s_cbranch_scc1 L_spd_102
    s_cmp_lt_u32 s64, 400000
    s_cbranch_scc1 L_sp_100
    s_branch L_spd_102
L_end:
    s_endpgm
.section .rodata,"a"
.p2align 6
.amdhsa_kernel parallel_sum__linear_kernel_hedgehog__dense_activation_squared_relu__prompt_kernel
  .amdhsa_next_free_vgpr 256
  .amdhsa_next_free_sgpr 102
  .amdhsa_accum_offset 128
  .amdhsa_group_segment_fixed_size 0
  .amdhsa_kernarg_size 96
  .amdhsa_user_sgpr_count 2
  .amdhsa_user_sgpr_kernarg_segment_ptr 1
  .amdhsa_system_sgpr_workgroup_id_x 1
.end_amdhsa_kernel
```
